```python
import torch

def _softmax(x, axis=-1):
    return torch.softmax(x, dim=axis)
def _gelu(x):
    return torch.nn.functional.gelu(x, approximate="tanh")
def _silu(x):
    return torch.nn.functional.silu(x)
def _sigmoid(x):
    return torch.sigmoid(x)
def _layernorm(x, axis=-1, eps=1e-5):
    m = x.mean(dim=axis, keepdim=True)
    v = x.var(dim=axis, keepdim=True, unbiased=False)
    return (x - m) / torch.sqrt(v + eps)
def _scatter_add(tgt, idx, src, axis=0):
    return tgt.clone().index_add_(axis, idx, src)
def _segment_sum(src, seg, n):
    out = torch.zeros((n,) + src.shape[1:], dtype=src.dtype)
    return out.index_add_(0, seg, src)
def _pad(x, pw):
    flat = tuple(v for pair in reversed(pw) for v in pair)
    return torch.nn.functional.pad(x, flat)

kernel_name = 'recurrent_scan__mha_block_cached__geglu_ffn__decode'

def setup_inputs():

    _w = (lambda a: (lambda t: t.to(torch.bfloat16) if t.is_floating_point() else t)(torch.as_tensor(a)))
    def _A_setup():
        B, Sq, D = 4, 1, 640
        H, Sk, Dh = 32, 8192, 128
        return {
            "x": _w((lambda *s: torch.randn(*s, dtype=torch.bfloat16) * 0.05)(B, Sq, D)),
            "k_cache": _w((lambda *s: torch.randn(*s, dtype=torch.bfloat16) * 1.6)(B, H, Sk, Dh)),
            "v_cache": _w((lambda *s: torch.randn(*s, dtype=torch.bfloat16) * 0.2)(B, H, Sk, Dh)),
            "wq": _w((lambda *s: torch.randn(*s, dtype=torch.bfloat16) * 1.6)(D, H * Dh) * (D ** -0.5)),
            "wo": _w((lambda *s: torch.randn(*s, dtype=torch.bfloat16) * 0.2)(H * Dh, D) * ((H * Dh) ** -0.5)),
        }
    _A_in = _A_setup()

    def _B_setup():
        B, S, D, F = 4, 1, 640, 1728
        return {
            "x": _w((lambda *s: torch.randn(*s, dtype=torch.bfloat16) * 0.05)(B, S, D)),
            "w_gate": _w((lambda *s: torch.randn(*s, dtype=torch.bfloat16) * 0.1)(D, F)),
            "w_up": _w((lambda *s: torch.randn(*s, dtype=torch.bfloat16) * 0.1)(D, F)),
            "w_down": _w((lambda *s: torch.randn(*s, dtype=torch.bfloat16) * 0.1)(F, D)),
        }
    _B_in = _B_setup()

    return {
        "A_x": _A_in["x"],
        "A_k_cache": _A_in["k_cache"],
        "A_v_cache": _A_in["v_cache"],
        "A_wq": _A_in["wq"],
        "A_wo": _A_in["wo"],
        "B_x": _B_in["x"],
        "B_w_gate": _B_in["w_gate"],
        "B_w_up": _B_in["w_up"],
        "B_w_down": _B_in["w_down"],
    }

def reference(A_x, A_k_cache, A_v_cache, A_wq, A_wo, B_x, B_w_gate, B_w_up, B_w_down):
    def _A_ref(x, k_cache, v_cache, wq, wo):
        B, Sq, D = x.shape
        H, Dh = 32, 128
        q = (lambda x, *d: x.permute(*d))((x @ wq).reshape(B, Sq, H, Dh), 0, 2, 1, 3)
        scores = torch.einsum("bhqd,bhkd->bhqk", q, k_cache) * (Dh ** -0.5)
        p = _softmax(scores, axis=-1)
        o = torch.einsum("bhqk,bhkd->bhqd", p, v_cache)
        return (lambda x, *d: x.permute(*d))(o, 0, 2, 1, 3).reshape(B, Sq, H * Dh) @ wo

    def _B_ref(x, w_gate, w_up, w_down):
        return (_gelu(x @ w_gate) * (x @ w_up)) @ w_down

    x = A_x
    xn = _layernorm(x, axis=-1)
    s = _A_ref(xn, A_k_cache, A_v_cache, A_wq, A_wo)
    g = _silu(_B_ref(xn, B_w_gate, B_w_up, B_w_down))
    return x + s * g
```

```asm
; @launch grid=(256,1,1) block=(512,1,1) lds=28160
.amdgcn_target "amdgcn-amd-amdhsa--gfx950"
.text
.globl recurrent_scan__mha_block_cached__geglu_ffn__decode_kernel
.p2align 8
.type recurrent_scan__mha_block_cached__geglu_ffn__decode_kernel,@function
recurrent_scan__mha_block_cached__geglu_ffn__decode_kernel:
  s_cmp_ge_u32 s2, 256
  s_cbranch_scc1 L_end
  s_load_dwordx16 s[4:19], s[0:1], 0
  s_load_dwordx8 s[20:27], s[0:1], 64
  v_lshrrev_b32 v2, 6, v0
  v_and_b32 v1, 63, v0
  v_readfirstlane_b32 s3, v2
  v_lshrrev_b32 v2, 4, v1
  v_and_b32 v3, 15, v1
  s_and_b32 s28, s2, 31
  s_lshr_b32 s29, s2, 5
  s_lshr_b32 s30, s29, 1
  s_lshr_b32 s31, s28, 3
  s_lshl_b32 s45, s30, 2
  s_add_u32 s31, s31, s45
  s_lshl_b32 s31, s31, 1
  s_and_b32 s45, s29, 1
  s_add_u32 s31, s31, s45
  s_and_b32 s89, s2, 7
  s_mov_b32 s41, 0x05040100
  s_mov_b32 s42, 0x07060302
  s_mov_b32 s44, 0x3fb8aa3b
  s_xor_b32 s3, s3, 4
  s_cmp_lt_u32 s3, 4
  s_cbranch_scc1 L_aux
  s_setprio 3
  s_lshl_b32 s45, s30, 5
  s_add_u32 s45, s45, s28
  s_mul_i32 s40, s45, 0
  s_and_b32 s40, s40, 0x1fe000
  s_lshl_b32 s45, s45, 21
  s_and_b32 s47, s29, 1
  s_sub_u32 s46, s3, 4
  s_lshl_b32 s54, s46, 1
  s_add_u32 s47, s47, s54
  s_lshl_b32 s47, s47, 10
  v_lshl_add_u32 v44, v1, 4, s47
  s_mov_b32 s34, 0x200000
  s_mov_b32 s35, 0x20000
  s_waitcnt lgkmcnt(0)
  s_add_u32 s32, s6, s45
  s_addc_u32 s33, s7, 0
  buffer_load_dwordx4 v[64:67], v44, s[32:35], s40 offen nt
  s_add_u32 s40, s40, 8192
  buffer_load_dwordx4 v[68:71], v44, s[32:35], s40 offen nt
  s_add_u32 s40, s40, 8192
  buffer_load_dwordx4 v[72:75], v44, s[32:35], s40 offen nt
  s_add_u32 s40, s40, 8192
  buffer_load_dwordx4 v[76:79], v44, s[32:35], s40 offen nt
  s_add_u32 s40, s40, 8192
  buffer_load_dwordx4 v[80:83], v44, s[32:35], s40 offen nt
  s_add_u32 s40, s40, 8192
  s_add_u32 s36, s8, s45
  s_addc_u32 s37, s9, 0
  s_mov_b32 s43, 0x3db504f3
  v_lshlrev_b32 v45, 4, v3
  v_mov_b32 v16, 0xff800000
  v_mov_b32 v8, 0
  v_mov_b32 v9, 0
  v_mov_b32 v10, 0
  v_mov_b32 v11, 0
  v_mov_b32 v12, 0
  v_mov_b32 v13, 0
  v_mov_b32 v14, 0
  v_mov_b32 v15, 0
  s_lshl_b32 s47, s46, 2
  v_add_u32 v46, s47, v2
  v_lshlrev_b32 v47, 2, v46
  v_mul_u32_u24 v46, 272, v46
  v_lshl_add_u32 v46, v3, 4, v46
  v_mov_b32 v58, 0
  v_mov_b32 v59, s47
  v_mov_b32 v62, 0
  s_load_dword s61, s[26:27], 0
  s_mov_b32 s48, 0x22222222
  s_mov_b32 s49, 0x22222222
  s_mov_b32 s50, 0x44444444
  s_mov_b32 s51, 0x44444444
  s_mov_b32 s52, 0x88888888
  s_mov_b32 s53, 0x88888888
  s_waitcnt vmcnt(4)
  buffer_load_dwordx4 v[84:87], v44, s[32:35], s40 offen nt
  s_add_u32 s40, s40, 8192
  s_waitcnt vmcnt(4)
  buffer_load_dwordx4 v[88:91], v44, s[32:35], s40 offen nt
  s_add_u32 s40, s40, 8192
  s_waitcnt vmcnt(4)
  buffer_load_dwordx4 v[92:95], v44, s[32:35], s40 offen nt
  s_add_u32 s40, s40, 8192
  s_waitcnt vmcnt(4)
  buffer_load_dwordx4 v[96:99], v44, s[32:35], s40 offen nt
  s_add_u32 s40, s40, 8192
  s_waitcnt vmcnt(4)
  buffer_load_dwordx4 v[100:103], v44, s[32:35], s40 offen nt
  s_add_u32 s40, s40, 8192
  s_waitcnt vmcnt(4)
  buffer_load_dwordx4 v[104:107], v44, s[32:35], s40 offen nt
  s_add_u32 s40, s40, 8192
  s_waitcnt vmcnt(4)
  buffer_load_dwordx4 v[108:111], v44, s[32:35], s40 offen nt
  s_add_u32 s40, s40, 8192
  s_waitcnt vmcnt(4)
  buffer_load_dwordx4 v[112:115], v44, s[32:35], s40 offen nt
  s_add_u32 s40, s40, 8192
  s_waitcnt vmcnt(4)
  buffer_load_dwordx4 v[116:119], v44, s[32:35], s40 offen nt
  s_add_u32 s40, s40, 8192
  s_waitcnt vmcnt(4)
  buffer_load_dwordx4 v[120:123], v44, s[32:35], s40 offen nt
  s_add_u32 s40, s40, 8192
  s_waitcnt vmcnt(4)
  buffer_load_dwordx4 v[124:127], v44, s[32:35], s40 offen nt
  s_add_u32 s40, s40, 8192
  s_waitcnt vmcnt(4)
  buffer_load_dwordx4 v[128:131], v44, s[32:35], s40 offen nt
  s_add_u32 s40, s40, 8192
  s_waitcnt vmcnt(4)
  buffer_load_dwordx4 v[132:135], v44, s[32:35], s40 offen nt
  s_add_u32 s40, s40, 8192
  s_waitcnt vmcnt(4)
  buffer_load_dwordx4 v[136:139], v44, s[32:35], s40 offen nt
  s_add_u32 s40, s40, 8192
  s_waitcnt vmcnt(4)
  buffer_load_dwordx4 v[140:143], v44, s[32:35], s40 offen nt
  s_add_u32 s40, s40, 8192
  s_waitcnt vmcnt(4)
  buffer_load_dwordx4 v[144:147], v44, s[32:35], s40 offen nt
  s_add_u32 s40, s40, 8192
  s_waitcnt vmcnt(4)
  buffer_load_dwordx4 v[148:151], v44, s[32:35], s40 offen nt
  s_add_u32 s40, s40, 8192
  s_waitcnt vmcnt(4)
  buffer_load_dwordx4 v[152:155], v44, s[32:35], s40 offen nt
  s_add_u32 s40, s40, 8192
  s_waitcnt vmcnt(4)
  buffer_load_dwordx4 v[156:159], v44, s[32:35], s40 offen nt
  s_add_u32 s40, s40, 8192
  s_waitcnt vmcnt(4)
  buffer_load_dwordx4 v[160:163], v44, s[32:35], s40 offen nt
  s_add_u32 s40, s40, 8192
  s_waitcnt vmcnt(4)
  buffer_load_dwordx4 v[164:167], v44, s[32:35], s40 offen nt
  s_add_u32 s40, s40, 8192
  s_waitcnt vmcnt(4)
  buffer_load_dwordx4 v[168:171], v44, s[32:35], s40 offen nt
  s_add_u32 s40, s40, 8192
  s_waitcnt vmcnt(4)
  buffer_load_dwordx4 v[172:175], v44, s[32:35], s40 offen nt
  s_add_u32 s40, s40, 8192
  s_waitcnt vmcnt(4)
  buffer_load_dwordx4 v[176:179], v44, s[32:35], s40 offen nt
  s_add_u32 s40, s40, 8192
  s_waitcnt vmcnt(4)
  buffer_load_dwordx4 v[180:183], v44, s[32:35], s40 offen nt
  s_add_u32 s40, s40, 8192
  s_waitcnt vmcnt(4)
  buffer_load_dwordx4 v[184:187], v44, s[32:35], s40 offen nt
  s_add_u32 s40, s40, 8192
  s_waitcnt vmcnt(4)
  buffer_load_dwordx4 v[188:191], v44, s[32:35], s40 offen nt
  s_add_u32 s40, s40, 8192
  s_waitcnt vmcnt(4)
  buffer_load_dwordx4 v[192:195], v44, s[32:35], s40 offen nt
  s_add_u32 s40, s40, 8192
  s_waitcnt vmcnt(4)
  buffer_load_dwordx4 v[196:199], v44, s[32:35], s40 offen nt
  s_add_u32 s40, s40, 8192
  s_waitcnt vmcnt(4)
  buffer_load_dwordx4 v[200:203], v44, s[32:35], s40 offen nt
  s_add_u32 s40, s40, 8192
  s_waitcnt vmcnt(4)
  buffer_load_dwordx4 v[204:207], v44, s[32:35], s40 offen nt
  s_add_u32 s40, s40, 8192
  s_waitcnt vmcnt(4)
  buffer_load_dwordx4 v[208:211], v44, s[32:35], s40 offen nt
  s_add_u32 s40, s40, 8192
  s_waitcnt vmcnt(4)
  buffer_load_dwordx4 v[212:215], v44, s[32:35], s40 offen nt
  s_add_u32 s40, s40, 8192
  s_waitcnt vmcnt(4)
  buffer_load_dwordx4 v[216:219], v44, s[32:35], s40 offen nt
  s_add_u32 s40, s40, 8192
  s_waitcnt vmcnt(4)
  buffer_load_dwordx4 v[220:223], v44, s[32:35], s40 offen nt
  s_add_u32 s40, s40, 8192
  s_waitcnt vmcnt(4)
  buffer_load_dwordx4 v[224:227], v44, s[32:35], s40 offen nt
  s_add_u32 s40, s40, 8192
  s_waitcnt vmcnt(4)
  buffer_load_dwordx4 v[228:231], v44, s[32:35], s40 offen nt
  s_add_u32 s40, s40, 8192
  s_waitcnt vmcnt(4)
  buffer_load_dwordx4 v[232:235], v44, s[32:35], s40 offen nt
  s_add_u32 s40, s40, 8192
  s_waitcnt vmcnt(4)
  buffer_load_dwordx4 v[236:239], v44, s[32:35], s40 offen nt
  s_add_u32 s40, s40, 8192
  s_waitcnt vmcnt(4)
  buffer_load_dwordx4 v[240:243], v44, s[32:35], s40 offen nt
  s_add_u32 s40, s40, 8192
  s_waitcnt vmcnt(4)
  buffer_load_dwordx4 v[244:247], v44, s[32:35], s40 offen nt
  s_add_u32 s40, s40, 8192
  s_waitcnt vmcnt(4)
  buffer_load_dwordx4 v[248:251], v44, s[32:35], s40 offen nt
  s_add_u32 s40, s40, 8192
  s_waitcnt vmcnt(4)
  buffer_load_dwordx4 v[252:255], v44, s[32:35], s40 offen nt
  s_add_u32 s40, s40, 8192
  s_waitcnt lgkmcnt(0)
  s_barrier
  ds_read_b128 v[4:7], v45 offset:21504
  s_waitcnt lgkmcnt(0)
  v_dot2_f32_bf16 v20, v64, v4, 0
  v_dot2_f32_bf16 v21, v68, v4, 0
  v_dot2_f32_bf16 v22, v72, v4, 0
  v_dot2_f32_bf16 v23, v76, v4, 0
  v_dot2_f32_bf16 v20, v65, v5, v20
  v_dot2_f32_bf16 v21, v69, v5, v21
  v_dot2_f32_bf16 v22, v73, v5, v22
  v_dot2_f32_bf16 v23, v77, v5, v23
  v_dot2_f32_bf16 v20, v66, v6, v20
  v_dot2_f32_bf16 v21, v70, v6, v21
  v_dot2_f32_bf16 v22, v74, v6, v22
  v_dot2_f32_bf16 v23, v78, v6, v23
  v_dot2_f32_bf16 v20, v67, v7, v20
  v_dot2_f32_bf16 v21, v71, v7, v21
  v_dot2_f32_bf16 v22, v75, v7, v22
  v_dot2_f32_bf16 v23, v79, v7, v23
  v_dot2_f32_bf16 v24, v80, v4, 0
  v_dot2_f32_bf16 v25, v84, v4, 0
  v_dot2_f32_bf16 v26, v88, v4, 0
  v_dot2_f32_bf16 v27, v92, v4, 0
  v_dot2_f32_bf16 v24, v81, v5, v24
  v_dot2_f32_bf16 v25, v85, v5, v25
  v_dot2_f32_bf16 v26, v89, v5, v26
  v_dot2_f32_bf16 v27, v93, v5, v27
  v_dot2_f32_bf16 v24, v82, v6, v24
  v_dot2_f32_bf16 v25, v86, v6, v25
  v_dot2_f32_bf16 v26, v90, v6, v26
  v_dot2_f32_bf16 v27, v94, v6, v27
  v_dot2_f32_bf16 v24, v83, v7, v24
  v_dot2_f32_bf16 v25, v87, v7, v25
  v_dot2_f32_bf16 v26, v91, v7, v26
  v_dot2_f32_bf16 v27, v95, v7, v27
  v_add_f32_dpp v20, v20, v20 row_ror:8 row_mask:0xf bank_mask:0x3
  v_add_f32_dpp v21, v21, v21 row_ror:8 row_mask:0xf bank_mask:0x3
  v_add_f32_dpp v24, v24, v24 row_ror:8 row_mask:0xf bank_mask:0x3
  v_add_f32_dpp v25, v25, v25 row_ror:8 row_mask:0xf bank_mask:0x3
  v_add_f32_dpp v20, v22, v22 row_ror:8 row_mask:0xf bank_mask:0xc
  v_add_f32_dpp v21, v23, v23 row_ror:8 row_mask:0xf bank_mask:0xc
  v_add_f32_dpp v24, v26, v26 row_ror:8 row_mask:0xf bank_mask:0xc
  v_add_f32_dpp v25, v27, v27 row_ror:8 row_mask:0xf bank_mask:0xc
  v_add_f32_dpp v20, v20, v20 row_half_mirror row_mask:0xf bank_mask:0x5
  v_mov_b32 v28, v30
  v_add_f32_dpp v21, v21, v21 row_half_mirror row_mask:0xf bank_mask:0x5
  v_mov_b32 v29, v31
  v_add_f32_dpp v20, v24, v24 row_half_mirror row_mask:0xf bank_mask:0xa
  v_mov_b32 v30, v32
  v_add_f32_dpp v21, v25, v25 row_half_mirror row_mask:0xf bank_mask:0xa
  v_mov_b32 v31, v33
  v_add_f32_dpp v20, v20, v20 quad_perm:[1,0,3,2] row_mask:0xf bank_mask:0xf
  v_mov_b32 v32, v34
  v_add_f32_dpp v21, v21, v21 quad_perm:[1,0,3,2] row_mask:0xf bank_mask:0xf
  v_mov_b32 v33, v35
  v_add_f32_dpp v56, v20, v20 quad_perm:[2,3,0,1] row_mask:0xf bank_mask:0xf
  v_mov_b32 v34, v36
  v_add_f32_dpp v57, v21, v21 quad_perm:[2,3,0,1] row_mask:0xf bank_mask:0xf
  v_dot2_f32_bf16 v20, v96, v4, 0
  v_dot2_f32_bf16 v21, v100, v4, 0
  v_dot2_f32_bf16 v22, v104, v4, 0
  v_dot2_f32_bf16 v23, v108, v4, 0
  v_dot2_f32_bf16 v20, v97, v5, v20
  v_dot2_f32_bf16 v21, v101, v5, v21
  v_dot2_f32_bf16 v22, v105, v5, v22
  v_dot2_f32_bf16 v23, v109, v5, v23
  v_dot2_f32_bf16 v20, v98, v6, v20
  v_dot2_f32_bf16 v21, v102, v6, v21
  v_dot2_f32_bf16 v22, v106, v6, v22
  v_dot2_f32_bf16 v23, v110, v6, v23
  v_dot2_f32_bf16 v20, v99, v7, v20
  v_dot2_f32_bf16 v21, v103, v7, v21
  v_dot2_f32_bf16 v22, v107, v7, v22
  v_dot2_f32_bf16 v23, v111, v7, v23
  v_dot2_f32_bf16 v24, v112, v4, 0
  v_dot2_f32_bf16 v25, v116, v4, 0
  v_dot2_f32_bf16 v26, v120, v4, 0
  v_dot2_f32_bf16 v27, v124, v4, 0
  v_dot2_f32_bf16 v24, v113, v5, v24
  v_dot2_f32_bf16 v25, v117, v5, v25
  v_dot2_f32_bf16 v26, v121, v5, v26
  v_dot2_f32_bf16 v27, v125, v5, v27
  v_dot2_f32_bf16 v24, v114, v6, v24
  v_dot2_f32_bf16 v25, v118, v6, v25
  v_dot2_f32_bf16 v26, v122, v6, v26
  v_dot2_f32_bf16 v27, v126, v6, v27
  v_dot2_f32_bf16 v24, v115, v7, v24
  v_dot2_f32_bf16 v25, v119, v7, v25
  v_dot2_f32_bf16 v26, v123, v7, v26
  v_dot2_f32_bf16 v27, v127, v7, v27
  v_add_f32_dpp v20, v20, v20 row_ror:8 row_mask:0xf bank_mask:0x3
  v_add_f32_dpp v21, v21, v21 row_ror:8 row_mask:0xf bank_mask:0x3
  v_add_f32_dpp v24, v24, v24 row_ror:8 row_mask:0xf bank_mask:0x3
  v_add_f32_dpp v25, v25, v25 row_ror:8 row_mask:0xf bank_mask:0x3
  v_add_f32_dpp v20, v22, v22 row_ror:8 row_mask:0xf bank_mask:0xc
  v_add_f32_dpp v21, v23, v23 row_ror:8 row_mask:0xf bank_mask:0xc
  v_add_f32_dpp v24, v26, v26 row_ror:8 row_mask:0xf bank_mask:0xc
  v_add_f32_dpp v25, v27, v27 row_ror:8 row_mask:0xf bank_mask:0xc
  v_add_f32_dpp v20, v20, v20 row_half_mirror row_mask:0xf bank_mask:0x5
  v_mov_b32 v35, v37
  v_add_f32_dpp v21, v21, v21 row_half_mirror row_mask:0xf bank_mask:0x5
  v_mov_b32 v36, v38
  v_add_f32_dpp v20, v24, v24 row_half_mirror row_mask:0xf bank_mask:0xa
  v_mov_b32 v37, v39
  v_add_f32_dpp v21, v25, v25 row_half_mirror row_mask:0xf bank_mask:0xa
  v_mov_b32 v38, v40
  v_add_f32_dpp v20, v20, v20 quad_perm:[1,0,3,2] row_mask:0xf bank_mask:0xf
  v_mov_b32 v39, v41
  v_add_f32_dpp v21, v21, v21 quad_perm:[1,0,3,2] row_mask:0xf bank_mask:0xf
  v_mov_b32 v40, v42
  v_add_f32_dpp v20, v20, v20 quad_perm:[2,3,0,1] row_mask:0xf bank_mask:0xf
  v_mov_b32 v41, v43
  v_add_f32_dpp v21, v21, v21 quad_perm:[2,3,0,1] row_mask:0xf bank_mask:0xf
  v_cndmask_b32 v56, v56, v20, s[48:49]
  v_cndmask_b32 v57, v57, v21, s[48:49]
  v_dot2_f32_bf16 v20, v128, v4, 0
  v_dot2_f32_bf16 v21, v132, v4, 0
  v_dot2_f32_bf16 v22, v136, v4, 0
  v_dot2_f32_bf16 v23, v140, v4, 0
  v_dot2_f32_bf16 v20, v129, v5, v20
  v_dot2_f32_bf16 v21, v133, v5, v21
  v_dot2_f32_bf16 v22, v137, v5, v22
  v_dot2_f32_bf16 v23, v141, v5, v23
  v_dot2_f32_bf16 v20, v130, v6, v20
  v_dot2_f32_bf16 v21, v134, v6, v21
  v_dot2_f32_bf16 v22, v138, v6, v22
  v_dot2_f32_bf16 v23, v142, v6, v23
  v_dot2_f32_bf16 v20, v131, v7, v20
  s_waitcnt vmcnt(4)
  buffer_load_dwordx4 v[128:131], v44, s[32:35], s40 offen nt
  s_add_u32 s40, s40, 8192
  v_dot2_f32_bf16 v21, v135, v7, v21
  s_waitcnt vmcnt(4)
  buffer_load_dwordx4 v[132:135], v44, s[32:35], s40 offen nt
  s_add_u32 s40, s40, 8192
  v_dot2_f32_bf16 v22, v139, v7, v22
  s_waitcnt vmcnt(4)
  buffer_load_dwordx4 v[136:139], v44, s[32:35], s40 offen nt
  s_add_u32 s40, s40, 8192
  v_dot2_f32_bf16 v23, v143, v7, v23
  s_waitcnt vmcnt(4)
  buffer_load_dwordx4 v[140:143], v44, s[32:35], s40 offen nt
  s_add_u32 s40, s40, 8192
  v_dot2_f32_bf16 v24, v144, v4, 0
  v_dot2_f32_bf16 v25, v148, v4, 0
  v_dot2_f32_bf16 v26, v152, v4, 0
  v_dot2_f32_bf16 v27, v156, v4, 0
  v_dot2_f32_bf16 v24, v145, v5, v24
  v_dot2_f32_bf16 v25, v149, v5, v25
  v_dot2_f32_bf16 v26, v153, v5, v26
  v_dot2_f32_bf16 v27, v157, v5, v27
  v_dot2_f32_bf16 v24, v146, v6, v24
  v_dot2_f32_bf16 v25, v150, v6, v25
  v_dot2_f32_bf16 v26, v154, v6, v26
  v_dot2_f32_bf16 v27, v158, v6, v27
  v_dot2_f32_bf16 v24, v147, v7, v24
  s_waitcnt vmcnt(4)
  buffer_load_dwordx4 v[144:147], v44, s[32:35], s40 offen nt
  s_add_u32 s40, s40, 8192
  v_dot2_f32_bf16 v25, v151, v7, v25
  s_waitcnt vmcnt(4)
  buffer_load_dwordx4 v[148:151], v44, s[32:35], s40 offen nt
  s_add_u32 s40, s40, 8192
  v_dot2_f32_bf16 v26, v155, v7, v26
  s_waitcnt vmcnt(4)
  buffer_load_dwordx4 v[152:155], v44, s[32:35], s40 offen nt
  s_add_u32 s40, s40, 8192
  v_dot2_f32_bf16 v27, v159, v7, v27
  s_waitcnt vmcnt(4)
  buffer_load_dwordx4 v[156:159], v44, s[32:35], s40 offen nt
  s_add_u32 s40, s40, 8192
  v_add_f32_dpp v20, v20, v20 row_ror:8 row_mask:0xf bank_mask:0x3
  v_add_f32_dpp v21, v21, v21 row_ror:8 row_mask:0xf bank_mask:0x3
  v_add_f32_dpp v24, v24, v24 row_ror:8 row_mask:0xf bank_mask:0x3
  v_add_f32_dpp v25, v25, v25 row_ror:8 row_mask:0xf bank_mask:0x3
  v_add_f32_dpp v20, v22, v22 row_ror:8 row_mask:0xf bank_mask:0xc
  v_add_f32_dpp v21, v23, v23 row_ror:8 row_mask:0xf bank_mask:0xc
  v_add_f32_dpp v24, v26, v26 row_ror:8 row_mask:0xf bank_mask:0xc
  v_add_f32_dpp v25, v27, v27 row_ror:8 row_mask:0xf bank_mask:0xc
  v_add_f32_dpp v20, v20, v20 row_half_mirror row_mask:0xf bank_mask:0x5
  v_add_f32_dpp v21, v21, v21 row_half_mirror row_mask:0xf bank_mask:0x5
  s_nop 0
  v_add_f32_dpp v20, v24, v24 row_half_mirror row_mask:0xf bank_mask:0xa
  v_add_f32_dpp v21, v25, v25 row_half_mirror row_mask:0xf bank_mask:0xa
  s_nop 0
  v_add_f32_dpp v20, v20, v20 quad_perm:[1,0,3,2] row_mask:0xf bank_mask:0xf
  v_add_f32_dpp v21, v21, v21 quad_perm:[1,0,3,2] row_mask:0xf bank_mask:0xf
  s_nop 0
  v_add_f32_dpp v20, v20, v20 quad_perm:[2,3,0,1] row_mask:0xf bank_mask:0xf
  v_add_f32_dpp v21, v21, v21 quad_perm:[2,3,0,1] row_mask:0xf bank_mask:0xf
  v_cndmask_b32 v56, v56, v20, s[50:51]
  v_cndmask_b32 v57, v57, v21, s[50:51]
  v_dot2_f32_bf16 v20, v160, v4, 0
  v_dot2_f32_bf16 v21, v164, v4, 0
  v_dot2_f32_bf16 v22, v168, v4, 0
  v_dot2_f32_bf16 v23, v172, v4, 0
  v_dot2_f32_bf16 v20, v161, v5, v20
  v_dot2_f32_bf16 v21, v165, v5, v21
  v_dot2_f32_bf16 v22, v169, v5, v22
  v_dot2_f32_bf16 v23, v173, v5, v23
  v_dot2_f32_bf16 v20, v162, v6, v20
  v_dot2_f32_bf16 v21, v166, v6, v21
  v_dot2_f32_bf16 v22, v170, v6, v22
  v_dot2_f32_bf16 v23, v174, v6, v23
  v_dot2_f32_bf16 v20, v163, v7, v20
  s_waitcnt vmcnt(4)
  buffer_load_dwordx4 v[160:163], v44, s[32:35], s40 offen nt
  s_add_u32 s40, s40, 8192
  v_dot2_f32_bf16 v21, v167, v7, v21
  s_waitcnt vmcnt(4)
  buffer_load_dwordx4 v[164:167], v44, s[32:35], s40 offen nt
  s_add_u32 s40, s40, 8192
  v_dot2_f32_bf16 v22, v171, v7, v22
  s_waitcnt vmcnt(4)
  buffer_load_dwordx4 v[168:171], v44, s[32:35], s40 offen nt
  s_add_u32 s40, s40, 8192
  v_dot2_f32_bf16 v23, v175, v7, v23
  s_waitcnt vmcnt(4)
  buffer_load_dwordx4 v[172:175], v44, s[32:35], s40 offen nt
  s_add_u32 s40, s40, 8192
  v_dot2_f32_bf16 v24, v176, v4, 0
  v_dot2_f32_bf16 v25, v180, v4, 0
  v_dot2_f32_bf16 v26, v184, v4, 0
  v_dot2_f32_bf16 v27, v188, v4, 0
  v_dot2_f32_bf16 v24, v177, v5, v24
  v_dot2_f32_bf16 v25, v181, v5, v25
  v_dot2_f32_bf16 v26, v185, v5, v26
  v_dot2_f32_bf16 v27, v189, v5, v27
  v_dot2_f32_bf16 v24, v178, v6, v24
  v_dot2_f32_bf16 v25, v182, v6, v25
  v_dot2_f32_bf16 v26, v186, v6, v26
  v_dot2_f32_bf16 v27, v190, v6, v27
  v_dot2_f32_bf16 v24, v179, v7, v24
  s_waitcnt vmcnt(4)
  buffer_load_dwordx4 v[176:179], v44, s[32:35], s40 offen nt
  s_add_u32 s40, s40, 8192
  v_dot2_f32_bf16 v25, v183, v7, v25
  s_waitcnt vmcnt(4)
  buffer_load_dwordx4 v[180:183], v44, s[32:35], s40 offen nt
  s_add_u32 s40, s40, 8192
  v_dot2_f32_bf16 v26, v187, v7, v26
  v_dot2_f32_bf16 v27, v191, v7, v27
  v_add_f32_dpp v20, v20, v20 row_ror:8 row_mask:0xf bank_mask:0x3
  v_add_f32_dpp v21, v21, v21 row_ror:8 row_mask:0xf bank_mask:0x3
  v_add_f32_dpp v24, v24, v24 row_ror:8 row_mask:0xf bank_mask:0x3
  v_add_f32_dpp v25, v25, v25 row_ror:8 row_mask:0xf bank_mask:0x3
  v_add_f32_dpp v20, v22, v22 row_ror:8 row_mask:0xf bank_mask:0xc
  v_add_f32_dpp v21, v23, v23 row_ror:8 row_mask:0xf bank_mask:0xc
  v_add_f32_dpp v24, v26, v26 row_ror:8 row_mask:0xf bank_mask:0xc
  v_add_f32_dpp v25, v27, v27 row_ror:8 row_mask:0xf bank_mask:0xc
  v_add_f32_dpp v20, v20, v20 row_half_mirror row_mask:0xf bank_mask:0x5
  v_add_f32_dpp v21, v21, v21 row_half_mirror row_mask:0xf bank_mask:0x5
  s_nop 0
  v_add_f32_dpp v20, v24, v24 row_half_mirror row_mask:0xf bank_mask:0xa
  v_add_f32_dpp v21, v25, v25 row_half_mirror row_mask:0xf bank_mask:0xa
  v_add_u32 v58, 1, v58
  ds_write_b32 v59, v58 offset:27008
  s_waitcnt vmcnt(4)
  buffer_load_dwordx4 v[184:187], v44, s[32:35], s40 offen nt
  s_add_u32 s40, s40, 8192
  v_add_f32_dpp v20, v20, v20 quad_perm:[1,0,3,2] row_mask:0xf bank_mask:0xf
  v_add_f32_dpp v21, v21, v21 quad_perm:[1,0,3,2] row_mask:0xf bank_mask:0xf
  s_nop 0
  v_add_f32_dpp v20, v20, v20 quad_perm:[2,3,0,1] row_mask:0xf bank_mask:0xf
  v_add_f32_dpp v21, v21, v21 quad_perm:[2,3,0,1] row_mask:0xf bank_mask:0xf
  v_cndmask_b32 v56, v56, v20, s[52:53]
  v_cndmask_b32 v57, v57, v21, s[52:53]
  v_cvt_pk_bf16_f32 v20, v56, v57
  v_lshlrev_b32 v56, 16, v20
  v_and_b32 v57, 0xffff0000, v20
  v_mul_f32 v56, s43, v56
  v_mul_f32 v57, s43, v57
  v_cvt_pk_bf16_f32 v20, v56, v57
  v_lshlrev_b32 v42, 16, v20
  v_and_b32 v43, 0xffff0000, v20
  v_max3_f32 v16, v16, v42, v43
  s_waitcnt vmcnt(4)
  buffer_load_dwordx4 v[188:191], v44, s[32:35], s40 offen nt
  s_add_u32 s40, s40, 8192
  v_dot2_f32_bf16 v20, v192, v4, 0
  v_dot2_f32_bf16 v21, v196, v4, 0
  v_dot2_f32_bf16 v22, v200, v4, 0
  v_dot2_f32_bf16 v23, v204, v4, 0
  v_dot2_f32_bf16 v20, v193, v5, v20
  v_dot2_f32_bf16 v21, v197, v5, v21
  v_dot2_f32_bf16 v22, v201, v5, v22
  v_dot2_f32_bf16 v23, v205, v5, v23
  v_dot2_f32_bf16 v20, v194, v6, v20
  v_dot2_f32_bf16 v21, v198, v6, v21
  v_dot2_f32_bf16 v22, v202, v6, v22
  v_dot2_f32_bf16 v23, v206, v6, v23
  v_dot2_f32_bf16 v20, v195, v7, v20
  v_dot2_f32_bf16 v21, v199, v7, v21
  v_dot2_f32_bf16 v22, v203, v7, v22
  s_waitcnt vmcnt(4)
  buffer_load_dwordx4 v[192:195], v44, s[32:35], s40 offen nt
  s_add_u32 s40, s40, 8192
  v_dot2_f32_bf16 v23, v207, v7, v23
  v_dot2_f32_bf16 v24, v208, v4, 0
  v_dot2_f32_bf16 v25, v212, v4, 0
  v_dot2_f32_bf16 v26, v216, v4, 0
  v_dot2_f32_bf16 v27, v220, v4, 0
  v_dot2_f32_bf16 v24, v209, v5, v24
  v_dot2_f32_bf16 v25, v213, v5, v25
  v_dot2_f32_bf16 v26, v217, v5, v26
  v_dot2_f32_bf16 v27, v221, v5, v27
  v_dot2_f32_bf16 v24, v210, v6, v24
  v_dot2_f32_bf16 v25, v214, v6, v25
  v_dot2_f32_bf16 v26, v218, v6, v26
  v_dot2_f32_bf16 v27, v222, v6, v27
  v_dot2_f32_bf16 v24, v211, v7, v24
  v_dot2_f32_bf16 v25, v215, v7, v25
  s_waitcnt vmcnt(4)
  buffer_load_dwordx4 v[196:199], v44, s[32:35], s40 offen nt
  s_add_u32 s40, s40, 8192
  v_dot2_f32_bf16 v26, v219, v7, v26
  v_dot2_f32_bf16 v27, v223, v7, v27
  v_add_f32_dpp v20, v20, v20 row_ror:8 row_mask:0xf bank_mask:0x3
  v_add_f32_dpp v21, v21, v21 row_ror:8 row_mask:0xf bank_mask:0x3
  v_add_f32_dpp v24, v24, v24 row_ror:8 row_mask:0xf bank_mask:0x3
  v_add_f32_dpp v25, v25, v25 row_ror:8 row_mask:0xf bank_mask:0x3
  v_add_f32_dpp v20, v22, v22 row_ror:8 row_mask:0xf bank_mask:0xc
  v_add_f32_dpp v21, v23, v23 row_ror:8 row_mask:0xf bank_mask:0xc
  v_add_f32_dpp v24, v26, v26 row_ror:8 row_mask:0xf bank_mask:0xc
  v_add_f32_dpp v25, v27, v27 row_ror:8 row_mask:0xf bank_mask:0xc
  v_add_f32_dpp v20, v20, v20 row_half_mirror row_mask:0xf bank_mask:0x5
  v_mov_b32 v28, v30
  v_add_f32_dpp v21, v21, v21 row_half_mirror row_mask:0xf bank_mask:0x5
  v_mov_b32 v29, v31
  s_waitcnt vmcnt(4)
  buffer_load_dwordx4 v[200:203], v44, s[32:35], s40 offen nt
  s_add_u32 s40, s40, 8192
  v_add_f32_dpp v20, v24, v24 row_half_mirror row_mask:0xf bank_mask:0xa
  v_mov_b32 v30, v32
  v_add_f32_dpp v21, v25, v25 row_half_mirror row_mask:0xf bank_mask:0xa
  v_mov_b32 v31, v33
  v_add_f32_dpp v20, v20, v20 quad_perm:[1,0,3,2] row_mask:0xf bank_mask:0xf
  v_mov_b32 v32, v34
  v_add_f32_dpp v21, v21, v21 quad_perm:[1,0,3,2] row_mask:0xf bank_mask:0xf
  v_mov_b32 v33, v35
  v_add_f32_dpp v56, v20, v20 quad_perm:[2,3,0,1] row_mask:0xf bank_mask:0xf
  v_mov_b32 v34, v36
  v_add_f32_dpp v57, v21, v21 quad_perm:[2,3,0,1] row_mask:0xf bank_mask:0xf
  v_dot2_f32_bf16 v20, v224, v4, 0
  v_dot2_f32_bf16 v21, v228, v4, 0
  v_dot2_f32_bf16 v22, v232, v4, 0
  v_dot2_f32_bf16 v23, v236, v4, 0
  s_waitcnt vmcnt(4)
  buffer_load_dwordx4 v[204:207], v44, s[32:35], s40 offen nt
  s_add_u32 s40, s40, 8192
  v_dot2_f32_bf16 v20, v225, v5, v20
  v_dot2_f32_bf16 v21, v229, v5, v21
  v_dot2_f32_bf16 v22, v233, v5, v22
  v_dot2_f32_bf16 v23, v237, v5, v23
  v_dot2_f32_bf16 v20, v226, v6, v20
  v_dot2_f32_bf16 v21, v230, v6, v21
  v_dot2_f32_bf16 v22, v234, v6, v22
  v_dot2_f32_bf16 v23, v238, v6, v23
  v_dot2_f32_bf16 v20, v227, v7, v20
  v_dot2_f32_bf16 v21, v231, v7, v21
  v_dot2_f32_bf16 v22, v235, v7, v22
  v_dot2_f32_bf16 v23, v239, v7, v23
  v_dot2_f32_bf16 v24, v240, v4, 0
  v_dot2_f32_bf16 v25, v244, v4, 0
  v_dot2_f32_bf16 v26, v248, v4, 0
  s_waitcnt vmcnt(4)
  buffer_load_dwordx4 v[208:211], v44, s[32:35], s40 offen nt
  s_add_u32 s40, s40, 8192
  v_dot2_f32_bf16 v27, v252, v4, 0
  v_dot2_f32_bf16 v24, v241, v5, v24
  v_dot2_f32_bf16 v25, v245, v5, v25
  v_dot2_f32_bf16 v26, v249, v5, v26
  v_dot2_f32_bf16 v27, v253, v5, v27
  v_dot2_f32_bf16 v24, v242, v6, v24
  v_dot2_f32_bf16 v25, v246, v6, v25
  v_dot2_f32_bf16 v26, v250, v6, v26
  v_dot2_f32_bf16 v27, v254, v6, v27
  v_dot2_f32_bf16 v24, v243, v7, v24
  v_dot2_f32_bf16 v25, v247, v7, v25
  v_dot2_f32_bf16 v26, v251, v7, v26
  v_dot2_f32_bf16 v27, v255, v7, v27
  v_add_f32_dpp v20, v20, v20 row_ror:8 row_mask:0xf bank_mask:0x3
  v_add_f32_dpp v21, v21, v21 row_ror:8 row_mask:0xf bank_mask:0x3
  s_waitcnt vmcnt(4)
  buffer_load_dwordx4 v[212:215], v44, s[32:35], s40 offen nt
  s_add_u32 s40, s40, 8192
  v_add_f32_dpp v24, v24, v24 row_ror:8 row_mask:0xf bank_mask:0x3
  v_add_f32_dpp v25, v25, v25 row_ror:8 row_mask:0xf bank_mask:0x3
  v_add_f32_dpp v20, v22, v22 row_ror:8 row_mask:0xf bank_mask:0xc
  v_add_f32_dpp v21, v23, v23 row_ror:8 row_mask:0xf bank_mask:0xc
  v_add_f32_dpp v24, v26, v26 row_ror:8 row_mask:0xf bank_mask:0xc
  v_add_f32_dpp v25, v27, v27 row_ror:8 row_mask:0xf bank_mask:0xc
  v_add_f32_dpp v20, v20, v20 row_half_mirror row_mask:0xf bank_mask:0x5
  v_mov_b32 v35, v37
  v_add_f32_dpp v21, v21, v21 row_half_mirror row_mask:0xf bank_mask:0x5
  v_mov_b32 v36, v38
  v_add_f32_dpp v20, v24, v24 row_half_mirror row_mask:0xf bank_mask:0xa
  v_mov_b32 v37, v39
  v_add_f32_dpp v21, v25, v25 row_half_mirror row_mask:0xf bank_mask:0xa
  v_mov_b32 v38, v40
  s_waitcnt vmcnt(4)
  buffer_load_dwordx4 v[216:219], v44, s[32:35], s40 offen nt
  s_add_u32 s40, s40, 8192
  v_add_f32_dpp v20, v20, v20 quad_perm:[1,0,3,2] row_mask:0xf bank_mask:0xf
  v_mov_b32 v39, v41
  v_add_f32_dpp v21, v21, v21 quad_perm:[1,0,3,2] row_mask:0xf bank_mask:0xf
  v_mov_b32 v40, v42
  v_add_f32_dpp v20, v20, v20 quad_perm:[2,3,0,1] row_mask:0xf bank_mask:0xf
  v_mov_b32 v41, v43
  v_add_f32_dpp v21, v21, v21 quad_perm:[2,3,0,1] row_mask:0xf bank_mask:0xf
  v_cndmask_b32 v56, v56, v20, s[48:49]
  v_cndmask_b32 v57, v57, v21, s[48:49]
  v_dot2_f32_bf16 v20, v128, v4, 0
  v_dot2_f32_bf16 v21, v132, v4, 0
  v_dot2_f32_bf16 v22, v136, v4, 0
  v_dot2_f32_bf16 v23, v140, v4, 0
  v_dot2_f32_bf16 v20, v129, v5, v20
  v_dot2_f32_bf16 v21, v133, v5, v21
  s_waitcnt vmcnt(4)
  buffer_load_dwordx4 v[220:223], v44, s[32:35], s40 offen nt
  s_add_u32 s40, s40, 8192
  v_dot2_f32_bf16 v22, v137, v5, v22
  v_dot2_f32_bf16 v23, v141, v5, v23
  v_dot2_f32_bf16 v20, v130, v6, v20
  v_dot2_f32_bf16 v21, v134, v6, v21
  v_dot2_f32_bf16 v22, v138, v6, v22
  v_dot2_f32_bf16 v23, v142, v6, v23
  v_dot2_f32_bf16 v20, v131, v7, v20
  v_dot2_f32_bf16 v21, v135, v7, v21
  v_dot2_f32_bf16 v22, v139, v7, v22
  v_dot2_f32_bf16 v23, v143, v7, v23
  v_dot2_f32_bf16 v24, v144, v4, 0
  v_dot2_f32_bf16 v25, v148, v4, 0
  v_dot2_f32_bf16 v26, v152, v4, 0
  v_dot2_f32_bf16 v27, v156, v4, 0
  v_dot2_f32_bf16 v24, v145, v5, v24
  s_waitcnt vmcnt(4)
  buffer_load_dwordx4 v[224:227], v44, s[32:35], s40 offen nt
  s_add_u32 s40, s40, 8192
  v_dot2_f32_bf16 v25, v149, v5, v25
  v_dot2_f32_bf16 v26, v153, v5, v26
  v_dot2_f32_bf16 v27, v157, v5, v27
  v_dot2_f32_bf16 v24, v146, v6, v24
  v_dot2_f32_bf16 v25, v150, v6, v25
  v_dot2_f32_bf16 v26, v154, v6, v26
  v_dot2_f32_bf16 v27, v158, v6, v27
  v_dot2_f32_bf16 v24, v147, v7, v24
  v_dot2_f32_bf16 v25, v151, v7, v25
  v_dot2_f32_bf16 v26, v155, v7, v26
  v_dot2_f32_bf16 v27, v159, v7, v27
  v_add_f32_dpp v20, v20, v20 row_ror:8 row_mask:0xf bank_mask:0x3
  v_add_f32_dpp v21, v21, v21 row_ror:8 row_mask:0xf bank_mask:0x3
  v_add_f32_dpp v24, v24, v24 row_ror:8 row_mask:0xf bank_mask:0x3
  v_add_f32_dpp v25, v25, v25 row_ror:8 row_mask:0xf bank_mask:0x3
  s_waitcnt vmcnt(4)
  buffer_load_dwordx4 v[228:231], v44, s[32:35], s40 offen nt
  s_add_u32 s40, s40, 8192
  v_add_f32_dpp v20, v22, v22 row_ror:8 row_mask:0xf bank_mask:0xc
  v_add_f32_dpp v21, v23, v23 row_ror:8 row_mask:0xf bank_mask:0xc
  v_add_f32_dpp v24, v26, v26 row_ror:8 row_mask:0xf bank_mask:0xc
  v_add_f32_dpp v25, v27, v27 row_ror:8 row_mask:0xf bank_mask:0xc
  v_add_f32_dpp v20, v20, v20 row_half_mirror row_mask:0xf bank_mask:0x5
  v_add_f32_dpp v21, v21, v21 row_half_mirror row_mask:0xf bank_mask:0x5
  s_nop 0
  v_add_f32_dpp v20, v24, v24 row_half_mirror row_mask:0xf bank_mask:0xa
  v_add_f32_dpp v21, v25, v25 row_half_mirror row_mask:0xf bank_mask:0xa
  s_nop 0
  v_add_f32_dpp v20, v20, v20 quad_perm:[1,0,3,2] row_mask:0xf bank_mask:0xf
  v_add_f32_dpp v21, v21, v21 quad_perm:[1,0,3,2] row_mask:0xf bank_mask:0xf
  s_nop 0
  v_add_f32_dpp v20, v20, v20 quad_perm:[2,3,0,1] row_mask:0xf bank_mask:0xf
  v_add_f32_dpp v21, v21, v21 quad_perm:[2,3,0,1] row_mask:0xf bank_mask:0xf
  v_cndmask_b32 v56, v56, v20, s[50:51]
  v_cndmask_b32 v57, v57, v21, s[50:51]
  s_waitcnt vmcnt(4)
  buffer_load_dwordx4 v[232:235], v44, s[32:35], s40 offen nt
  s_add_u32 s40, s40, 8192
  v_dot2_f32_bf16 v20, v160, v4, 0
  v_dot2_f32_bf16 v21, v164, v4, 0
  v_dot2_f32_bf16 v22, v168, v4, 0
  v_dot2_f32_bf16 v23, v172, v4, 0
  v_dot2_f32_bf16 v20, v161, v5, v20
  v_dot2_f32_bf16 v21, v165, v5, v21
  v_dot2_f32_bf16 v22, v169, v5, v22
  v_dot2_f32_bf16 v23, v173, v5, v23
  v_dot2_f32_bf16 v20, v162, v6, v20
  v_dot2_f32_bf16 v21, v166, v6, v21
  v_dot2_f32_bf16 v22, v170, v6, v22
  v_dot2_f32_bf16 v23, v174, v6, v23
  v_dot2_f32_bf16 v20, v163, v7, v20
  v_dot2_f32_bf16 v21, v167, v7, v21
  v_dot2_f32_bf16 v22, v171, v7, v22
  ds_read_b32 v61, v62 offset:27024
  s_waitcnt vmcnt(4)
  buffer_load_dwordx4 v[236:239], v44, s[32:35], s40 offen nt
  s_add_u32 s40, s40, 8192
  v_dot2_f32_bf16 v23, v175, v7, v23
  v_dot2_f32_bf16 v24, v176, v4, 0
  v_dot2_f32_bf16 v25, v180, v4, 0
  v_dot2_f32_bf16 v26, v184, v4, 0
  v_dot2_f32_bf16 v27, v188, v4, 0
  v_dot2_f32_bf16 v24, v177, v5, v24
  v_dot2_f32_bf16 v25, v181, v5, v25
  v_dot2_f32_bf16 v26, v185, v5, v26
  v_dot2_f32_bf16 v27, v189, v5, v27
  v_dot2_f32_bf16 v24, v178, v6, v24
  v_dot2_f32_bf16 v25, v182, v6, v25
  v_dot2_f32_bf16 v26, v186, v6, v26
  v_dot2_f32_bf16 v27, v190, v6, v27
  v_dot2_f32_bf16 v24, v179, v7, v24
  v_dot2_f32_bf16 v25, v183, v7, v25
  s_waitcnt vmcnt(4)
  buffer_load_dwordx4 v[240:243], v44, s[32:35], s40 offen nt
  s_add_u32 s40, s40, 8192
  v_dot2_f32_bf16 v26, v187, v7, v26
  v_dot2_f32_bf16 v27, v191, v7, v27
  v_add_f32_dpp v20, v20, v20 row_ror:8 row_mask:0xf bank_mask:0x3
  v_add_f32_dpp v21, v21, v21 row_ror:8 row_mask:0xf bank_mask:0x3
  v_add_f32_dpp v24, v24, v24 row_ror:8 row_mask:0xf bank_mask:0x3
  v_add_f32_dpp v25, v25, v25 row_ror:8 row_mask:0xf bank_mask:0x3
  v_add_f32_dpp v20, v22, v22 row_ror:8 row_mask:0xf bank_mask:0xc
  v_add_f32_dpp v21, v23, v23 row_ror:8 row_mask:0xf bank_mask:0xc
  v_add_f32_dpp v24, v26, v26 row_ror:8 row_mask:0xf bank_mask:0xc
  v_add_f32_dpp v25, v27, v27 row_ror:8 row_mask:0xf bank_mask:0xc
  v_add_f32_dpp v20, v20, v20 row_half_mirror row_mask:0xf bank_mask:0x5
  v_add_f32_dpp v21, v21, v21 row_half_mirror row_mask:0xf bank_mask:0x5
  s_nop 0
  v_add_f32_dpp v20, v24, v24 row_half_mirror row_mask:0xf bank_mask:0xa
  v_add_f32_dpp v21, v25, v25 row_half_mirror row_mask:0xf bank_mask:0xa
  s_nop 0
  v_add_f32_dpp v20, v20, v20 quad_perm:[1,0,3,2] row_mask:0xf bank_mask:0xf
  s_waitcnt vmcnt(4)
  buffer_load_dwordx4 v[244:247], v44, s[32:35], s40 offen nt
  s_add_u32 s40, s40, 8192
  v_add_f32_dpp v21, v21, v21 quad_perm:[1,0,3,2] row_mask:0xf bank_mask:0xf
  v_add_f32_dpp v20, v20, v20 quad_perm:[2,3,0,1] row_mask:0xf bank_mask:0xf
  s_nop 0
  v_add_f32_dpp v21, v21, v21 quad_perm:[2,3,0,1] row_mask:0xf bank_mask:0xf
  v_cndmask_b32 v56, v56, v20, s[52:53]
  v_cndmask_b32 v57, v57, v21, s[52:53]
  v_cvt_pk_bf16_f32 v20, v56, v57
  v_lshlrev_b32 v56, 16, v20
  v_and_b32 v57, 0xffff0000, v20
  v_mul_f32 v56, s43, v56
  v_mul_f32 v57, s43, v57
  v_cvt_pk_bf16_f32 v20, v56, v57
  v_lshlrev_b32 v42, 16, v20
  v_and_b32 v43, 0xffff0000, v20
  v_max3_f32 v16, v16, v42, v43
  s_mov_b32 s55, 6
  s_nop 0
L_kloop:
  s_waitcnt lgkmcnt(0)
  v_readfirstlane_b32 s56, v61
  s_nop 0
  s_cmp_lg_u32 s56, 0
  s_nop 1
  s_cbranch_scc1 L_kloop_f
  s_waitcnt vmcnt(4)
  buffer_load_dwordx4 v[248:251], v44, s[32:35], s40 offen nt
  s_add_u32 s40, s40, 8192
  v_dot2_f32_bf16 v20, v192, v4, 0
  v_dot2_f32_bf16 v21, v196, v4, 0
  v_dot2_f32_bf16 v22, v200, v4, 0
  v_dot2_f32_bf16 v23, v204, v4, 0
  v_dot2_f32_bf16 v20, v193, v5, v20
  v_dot2_f32_bf16 v21, v197, v5, v21
  v_dot2_f32_bf16 v22, v201, v5, v22
  s_waitcnt vmcnt(4)
  buffer_load_dwordx4 v[252:255], v44, s[32:35], s40 offen nt
  s_add_u32 s40, s40, 8192
  v_dot2_f32_bf16 v23, v205, v5, v23
  v_dot2_f32_bf16 v20, v194, v6, v20
  v_dot2_f32_bf16 v21, v198, v6, v21
  v_dot2_f32_bf16 v22, v202, v6, v22
  v_dot2_f32_bf16 v23, v206, v6, v23
  v_dot2_f32_bf16 v20, v195, v7, v20
  v_dot2_f32_bf16 v21, v199, v7, v21
  s_waitcnt vmcnt(4)
  buffer_load_dwordx4 v[128:131], v44, s[32:35], s40 offen nt
  s_add_u32 s40, s40, 8192
  v_dot2_f32_bf16 v22, v203, v7, v22
  v_dot2_f32_bf16 v23, v207, v7, v23
  v_dot2_f32_bf16 v24, v208, v4, 0
  v_dot2_f32_bf16 v25, v212, v4, 0
  v_dot2_f32_bf16 v26, v216, v4, 0
  v_dot2_f32_bf16 v27, v220, v4, 0
  v_dot2_f32_bf16 v24, v209, v5, v24
  s_waitcnt vmcnt(4)
  buffer_load_dwordx4 v[132:135], v44, s[32:35], s40 offen nt
  s_add_u32 s40, s40, 8192
  v_dot2_f32_bf16 v25, v213, v5, v25
  v_dot2_f32_bf16 v26, v217, v5, v26
  v_dot2_f32_bf16 v27, v221, v5, v27
  v_dot2_f32_bf16 v24, v210, v6, v24
  v_dot2_f32_bf16 v25, v214, v6, v25
  v_dot2_f32_bf16 v26, v218, v6, v26
  v_dot2_f32_bf16 v27, v222, v6, v27
  s_waitcnt vmcnt(4)
  buffer_load_dwordx4 v[136:139], v44, s[32:35], s40 offen nt
  s_add_u32 s40, s40, 8192
  v_dot2_f32_bf16 v24, v211, v7, v24
  v_dot2_f32_bf16 v25, v215, v7, v25
  v_dot2_f32_bf16 v26, v219, v7, v26
  v_dot2_f32_bf16 v27, v223, v7, v27
  v_add_f32_dpp v20, v20, v20 row_ror:8 row_mask:0xf bank_mask:0x3
  v_add_f32_dpp v21, v21, v21 row_ror:8 row_mask:0xf bank_mask:0x3
  v_add_f32_dpp v24, v24, v24 row_ror:8 row_mask:0xf bank_mask:0x3
  s_waitcnt vmcnt(4)
  buffer_load_dwordx4 v[140:143], v44, s[32:35], s40 offen nt
  s_add_u32 s40, s40, 8192
  v_add_f32_dpp v25, v25, v25 row_ror:8 row_mask:0xf bank_mask:0x3
  v_add_f32_dpp v20, v22, v22 row_ror:8 row_mask:0xf bank_mask:0xc
  v_add_f32_dpp v21, v23, v23 row_ror:8 row_mask:0xf bank_mask:0xc
  v_add_f32_dpp v24, v26, v26 row_ror:8 row_mask:0xf bank_mask:0xc
  v_add_f32_dpp v25, v27, v27 row_ror:8 row_mask:0xf bank_mask:0xc
  v_add_f32_dpp v20, v20, v20 row_half_mirror row_mask:0xf bank_mask:0x5
  v_mov_b32 v28, v30
  s_waitcnt vmcnt(4)
  buffer_load_dwordx4 v[144:147], v44, s[32:35], s40 offen nt
  s_add_u32 s40, s40, 8192
  v_add_f32_dpp v21, v21, v21 row_half_mirror row_mask:0xf bank_mask:0x5
  v_mov_b32 v29, v31
  v_add_f32_dpp v20, v24, v24 row_half_mirror row_mask:0xf bank_mask:0xa
  v_mov_b32 v30, v32
  v_add_f32_dpp v21, v25, v25 row_half_mirror row_mask:0xf bank_mask:0xa
  v_mov_b32 v31, v33
  v_add_f32_dpp v20, v20, v20 quad_perm:[1,0,3,2] row_mask:0xf bank_mask:0xf
  s_waitcnt vmcnt(4)
  buffer_load_dwordx4 v[148:151], v44, s[32:35], s40 offen nt
  s_add_u32 s40, s40, 8192
  v_mov_b32 v32, v34
  v_add_f32_dpp v21, v21, v21 quad_perm:[1,0,3,2] row_mask:0xf bank_mask:0xf
  v_mov_b32 v33, v35
  v_add_f32_dpp v56, v20, v20 quad_perm:[2,3,0,1] row_mask:0xf bank_mask:0xf
  v_mov_b32 v34, v36
  v_add_f32_dpp v57, v21, v21 quad_perm:[2,3,0,1] row_mask:0xf bank_mask:0xf
  v_dot2_f32_bf16 v20, v224, v4, 0
  s_waitcnt vmcnt(4)
  buffer_load_dwordx4 v[152:155], v44, s[32:35], s40 offen nt
  s_add_u32 s40, s40, 8192
  v_dot2_f32_bf16 v21, v228, v4, 0
  v_dot2_f32_bf16 v22, v232, v4, 0
  v_dot2_f32_bf16 v23, v236, v4, 0
  v_dot2_f32_bf16 v20, v225, v5, v20
  v_dot2_f32_bf16 v21, v229, v5, v21
  v_dot2_f32_bf16 v22, v233, v5, v22
  v_dot2_f32_bf16 v23, v237, v5, v23
  s_waitcnt vmcnt(4)
  buffer_load_dwordx4 v[156:159], v44, s[32:35], s40 offen nt
  s_add_u32 s40, s40, 8192
  v_dot2_f32_bf16 v20, v226, v6, v20
  v_dot2_f32_bf16 v21, v230, v6, v21
  v_dot2_f32_bf16 v22, v234, v6, v22
  v_dot2_f32_bf16 v23, v238, v6, v23
  v_dot2_f32_bf16 v20, v227, v7, v20
  v_dot2_f32_bf16 v21, v231, v7, v21
  v_dot2_f32_bf16 v22, v235, v7, v22
  s_waitcnt vmcnt(4)
  buffer_load_dwordx4 v[160:163], v44, s[32:35], s40 offen nt
  s_add_u32 s40, s40, 8192
  v_dot2_f32_bf16 v23, v239, v7, v23
  v_dot2_f32_bf16 v24, v240, v4, 0
  v_dot2_f32_bf16 v25, v244, v4, 0
  v_dot2_f32_bf16 v26, v248, v4, 0
  v_dot2_f32_bf16 v27, v252, v4, 0
  v_dot2_f32_bf16 v24, v241, v5, v24
  s_waitcnt vmcnt(4)
  buffer_load_dwordx4 v[164:167], v44, s[32:35], s40 offen nt
  s_add_u32 s40, s40, 8192
  v_dot2_f32_bf16 v25, v245, v5, v25
  v_dot2_f32_bf16 v26, v249, v5, v26
  v_dot2_f32_bf16 v27, v253, v5, v27
  v_dot2_f32_bf16 v24, v242, v6, v24
  v_dot2_f32_bf16 v25, v246, v6, v25
  v_dot2_f32_bf16 v26, v250, v6, v26
  v_dot2_f32_bf16 v27, v254, v6, v27
  s_waitcnt vmcnt(4)
  buffer_load_dwordx4 v[168:171], v44, s[32:35], s40 offen nt
  s_add_u32 s40, s40, 8192
  v_dot2_f32_bf16 v24, v243, v7, v24
  v_dot2_f32_bf16 v25, v247, v7, v25
  v_dot2_f32_bf16 v26, v251, v7, v26
  v_dot2_f32_bf16 v27, v255, v7, v27
  v_add_f32_dpp v20, v20, v20 row_ror:8 row_mask:0xf bank_mask:0x3
  v_add_f32_dpp v21, v21, v21 row_ror:8 row_mask:0xf bank_mask:0x3
  v_add_f32_dpp v24, v24, v24 row_ror:8 row_mask:0xf bank_mask:0x3
  s_waitcnt vmcnt(4)
  buffer_load_dwordx4 v[172:175], v44, s[32:35], s40 offen nt
  s_add_u32 s40, s40, 8192
  v_add_f32_dpp v25, v25, v25 row_ror:8 row_mask:0xf bank_mask:0x3
  v_add_f32_dpp v20, v22, v22 row_ror:8 row_mask:0xf bank_mask:0xc
  v_add_f32_dpp v21, v23, v23 row_ror:8 row_mask:0xf bank_mask:0xc
  v_add_f32_dpp v24, v26, v26 row_ror:8 row_mask:0xf bank_mask:0xc
  v_add_f32_dpp v25, v27, v27 row_ror:8 row_mask:0xf bank_mask:0xc
  v_add_f32_dpp v20, v20, v20 row_half_mirror row_mask:0xf bank_mask:0x5
  v_mov_b32 v35, v37
  s_waitcnt vmcnt(4)
  buffer_load_dwordx4 v[176:179], v44, s[32:35], s40 offen nt
  s_add_u32 s40, s40, 8192
  v_add_f32_dpp v21, v21, v21 row_half_mirror row_mask:0xf bank_mask:0x5
  v_mov_b32 v36, v38
  v_add_f32_dpp v20, v24, v24 row_half_mirror row_mask:0xf bank_mask:0xa
  v_mov_b32 v37, v39
  v_add_f32_dpp v21, v25, v25 row_half_mirror row_mask:0xf bank_mask:0xa
  v_mov_b32 v38, v40
  v_add_f32_dpp v20, v20, v20 quad_perm:[1,0,3,2] row_mask:0xf bank_mask:0xf
  s_waitcnt vmcnt(4)
  buffer_load_dwordx4 v[180:183], v44, s[32:35], s40 offen nt
  s_add_u32 s40, s40, 8192
  v_mov_b32 v39, v41
  v_add_f32_dpp v21, v21, v21 quad_perm:[1,0,3,2] row_mask:0xf bank_mask:0xf
  v_mov_b32 v40, v42
  v_add_f32_dpp v20, v20, v20 quad_perm:[2,3,0,1] row_mask:0xf bank_mask:0xf
  v_mov_b32 v41, v43
  v_add_f32_dpp v21, v21, v21 quad_perm:[2,3,0,1] row_mask:0xf bank_mask:0xf
  v_cndmask_b32 v56, v56, v20, s[48:49]
  v_add_u32 v58, 1, v58
  ds_write_b32 v59, v58 offset:27008
  s_waitcnt vmcnt(4)
  buffer_load_dwordx4 v[184:187], v44, s[32:35], s40 offen nt
  s_add_u32 s40, s40, 8192
  v_cndmask_b32 v57, v57, v21, s[48:49]
  v_dot2_f32_bf16 v20, v128, v4, 0
  v_dot2_f32_bf16 v21, v132, v4, 0
  v_dot2_f32_bf16 v22, v136, v4, 0
  v_dot2_f32_bf16 v23, v140, v4, 0
  v_dot2_f32_bf16 v20, v129, v5, v20
  v_dot2_f32_bf16 v21, v133, v5, v21
  s_waitcnt vmcnt(4)
  buffer_load_dwordx4 v[188:191], v44, s[32:35], s40 offen nt
  s_add_u32 s40, s40, 8192
  v_dot2_f32_bf16 v22, v137, v5, v22
  v_dot2_f32_bf16 v23, v141, v5, v23
  v_dot2_f32_bf16 v20, v130, v6, v20
  v_dot2_f32_bf16 v21, v134, v6, v21
  v_dot2_f32_bf16 v22, v138, v6, v22
  v_dot2_f32_bf16 v23, v142, v6, v23
  v_dot2_f32_bf16 v20, v131, v7, v20
  s_cmp_eq_u32 s55, 1
  s_cselect_b32 s32, s36, s32
  s_cselect_b32 s33, s37, s33
  s_cselect_b32 s40, 0, s40
  s_waitcnt vmcnt(4)
  buffer_load_dwordx4 v[192:195], v44, s[32:35], s40 offen nt
  s_add_u32 s40, s40, 8192
  v_dot2_f32_bf16 v21, v135, v7, v21
  v_dot2_f32_bf16 v22, v139, v7, v22
  v_dot2_f32_bf16 v23, v143, v7, v23
  v_dot2_f32_bf16 v24, v144, v4, 0
  v_dot2_f32_bf16 v25, v148, v4, 0
  v_dot2_f32_bf16 v26, v152, v4, 0
  v_dot2_f32_bf16 v27, v156, v4, 0
  s_waitcnt vmcnt(4)
  buffer_load_dwordx4 v[196:199], v44, s[32:35], s40 offen nt
  s_add_u32 s40, s40, 8192
  v_dot2_f32_bf16 v24, v145, v5, v24
  v_dot2_f32_bf16 v25, v149, v5, v25
  v_dot2_f32_bf16 v26, v153, v5, v26
  v_dot2_f32_bf16 v27, v157, v5, v27
  v_dot2_f32_bf16 v24, v146, v6, v24
  v_dot2_f32_bf16 v25, v150, v6, v25
  v_dot2_f32_bf16 v26, v154, v6, v26
  s_waitcnt vmcnt(4)
  buffer_load_dwordx4 v[200:203], v44, s[32:35], s40 offen nt
  s_add_u32 s40, s40, 8192
  v_dot2_f32_bf16 v27, v158, v6, v27
  v_dot2_f32_bf16 v24, v147, v7, v24
  v_dot2_f32_bf16 v25, v151, v7, v25
  v_dot2_f32_bf16 v26, v155, v7, v26
  v_dot2_f32_bf16 v27, v159, v7, v27
  v_add_f32_dpp v20, v20, v20 row_ror:8 row_mask:0xf bank_mask:0x3
  v_add_f32_dpp v21, v21, v21 row_ror:8 row_mask:0xf bank_mask:0x3
  s_waitcnt vmcnt(4)
  buffer_load_dwordx4 v[204:207], v44, s[32:35], s40 offen nt
  s_add_u32 s40, s40, 8192
  v_add_f32_dpp v24, v24, v24 row_ror:8 row_mask:0xf bank_mask:0x3
  v_add_f32_dpp v25, v25, v25 row_ror:8 row_mask:0xf bank_mask:0x3
  v_add_f32_dpp v20, v22, v22 row_ror:8 row_mask:0xf bank_mask:0xc
  v_add_f32_dpp v21, v23, v23 row_ror:8 row_mask:0xf bank_mask:0xc
  v_add_f32_dpp v24, v26, v26 row_ror:8 row_mask:0xf bank_mask:0xc
  v_add_f32_dpp v25, v27, v27 row_ror:8 row_mask:0xf bank_mask:0xc
  s_waitcnt vmcnt(4)
  buffer_load_dwordx4 v[208:211], v44, s[32:35], s40 offen nt
  s_add_u32 s40, s40, 8192
  v_add_f32_dpp v20, v20, v20 row_half_mirror row_mask:0xf bank_mask:0x5
  v_add_f32_dpp v21, v21, v21 row_half_mirror row_mask:0xf bank_mask:0x5
  s_nop 0
  v_add_f32_dpp v20, v24, v24 row_half_mirror row_mask:0xf bank_mask:0xa
  v_add_f32_dpp v21, v25, v25 row_half_mirror row_mask:0xf bank_mask:0xa
  s_nop 0
  v_add_f32_dpp v20, v20, v20 quad_perm:[1,0,3,2] row_mask:0xf bank_mask:0xf
  v_add_f32_dpp v21, v21, v21 quad_perm:[1,0,3,2] row_mask:0xf bank_mask:0xf
  s_nop 0
  v_add_f32_dpp v20, v20, v20 quad_perm:[2,3,0,1] row_mask:0xf bank_mask:0xf
  s_waitcnt vmcnt(4)
  buffer_load_dwordx4 v[212:215], v44, s[32:35], s40 offen nt
  s_add_u32 s40, s40, 8192
  v_add_f32_dpp v21, v21, v21 quad_perm:[2,3,0,1] row_mask:0xf bank_mask:0xf
  v_cndmask_b32 v56, v56, v20, s[50:51]
  v_cndmask_b32 v57, v57, v21, s[50:51]
  v_dot2_f32_bf16 v20, v160, v4, 0
  v_dot2_f32_bf16 v21, v164, v4, 0
  v_dot2_f32_bf16 v22, v168, v4, 0
  v_dot2_f32_bf16 v23, v172, v4, 0
  s_waitcnt vmcnt(4)
  buffer_load_dwordx4 v[216:219], v44, s[32:35], s40 offen nt
  s_add_u32 s40, s40, 8192
  v_dot2_f32_bf16 v20, v161, v5, v20
  v_dot2_f32_bf16 v21, v165, v5, v21
  v_dot2_f32_bf16 v22, v169, v5, v22
  v_dot2_f32_bf16 v23, v173, v5, v23
  v_dot2_f32_bf16 v20, v162, v6, v20
  v_dot2_f32_bf16 v21, v166, v6, v21
  v_dot2_f32_bf16 v22, v170, v6, v22
  s_waitcnt vmcnt(4)
  buffer_load_dwordx4 v[220:223], v44, s[32:35], s40 offen nt
  s_add_u32 s40, s40, 8192
  v_dot2_f32_bf16 v23, v174, v6, v23
  v_dot2_f32_bf16 v20, v163, v7, v20
  v_dot2_f32_bf16 v21, v167, v7, v21
  v_dot2_f32_bf16 v22, v171, v7, v22
  v_dot2_f32_bf16 v23, v175, v7, v23
  v_dot2_f32_bf16 v24, v176, v4, 0
  v_dot2_f32_bf16 v25, v180, v4, 0
  s_waitcnt vmcnt(4)
  buffer_load_dwordx4 v[224:227], v44, s[32:35], s40 offen nt
  s_add_u32 s40, s40, 8192
  v_dot2_f32_bf16 v26, v184, v4, 0
  v_dot2_f32_bf16 v27, v188, v4, 0
  v_dot2_f32_bf16 v24, v177, v5, v24
  v_dot2_f32_bf16 v25, v181, v5, v25
  v_dot2_f32_bf16 v26, v185, v5, v26
  v_dot2_f32_bf16 v27, v189, v5, v27
  v_dot2_f32_bf16 v24, v178, v6, v24
  s_waitcnt vmcnt(4)
  buffer_load_dwordx4 v[228:231], v44, s[32:35], s40 offen nt
  s_add_u32 s40, s40, 8192
  v_dot2_f32_bf16 v25, v182, v6, v25
  v_dot2_f32_bf16 v26, v186, v6, v26
  v_dot2_f32_bf16 v27, v190, v6, v27
  v_dot2_f32_bf16 v24, v179, v7, v24
  v_dot2_f32_bf16 v25, v183, v7, v25
  v_dot2_f32_bf16 v26, v187, v7, v26
  v_dot2_f32_bf16 v27, v191, v7, v27
  s_waitcnt vmcnt(4)
  buffer_load_dwordx4 v[232:235], v44, s[32:35], s40 offen nt
  s_add_u32 s40, s40, 8192
  v_add_f32_dpp v20, v20, v20 row_ror:8 row_mask:0xf bank_mask:0x3
  v_add_f32_dpp v21, v21, v21 row_ror:8 row_mask:0xf bank_mask:0x3
  v_add_f32_dpp v24, v24, v24 row_ror:8 row_mask:0xf bank_mask:0x3
  v_add_f32_dpp v25, v25, v25 row_ror:8 row_mask:0xf bank_mask:0x3
  v_add_f32_dpp v20, v22, v22 row_ror:8 row_mask:0xf bank_mask:0xc
  v_add_f32_dpp v21, v23, v23 row_ror:8 row_mask:0xf bank_mask:0xc
  v_add_f32_dpp v24, v26, v26 row_ror:8 row_mask:0xf bank_mask:0xc
  ds_read_b32 v61, v62 offset:27024
  s_waitcnt vmcnt(4)
  buffer_load_dwordx4 v[236:239], v44, s[32:35], s40 offen nt
  s_add_u32 s40, s40, 8192
  v_add_f32_dpp v25, v27, v27 row_ror:8 row_mask:0xf bank_mask:0xc
  v_add_f32_dpp v20, v20, v20 row_half_mirror row_mask:0xf bank_mask:0x5
  v_add_f32_dpp v21, v21, v21 row_half_mirror row_mask:0xf bank_mask:0x5
  s_nop 0
  v_add_f32_dpp v20, v24, v24 row_half_mirror row_mask:0xf bank_mask:0xa
  v_add_f32_dpp v21, v25, v25 row_half_mirror row_mask:0xf bank_mask:0xa
  s_nop 0
  v_add_f32_dpp v20, v20, v20 quad_perm:[1,0,3,2] row_mask:0xf bank_mask:0xf
  v_add_f32_dpp v21, v21, v21 quad_perm:[1,0,3,2] row_mask:0xf bank_mask:0xf
  s_waitcnt vmcnt(4)
  buffer_load_dwordx4 v[240:243], v44, s[32:35], s40 offen nt
  s_add_u32 s40, s40, 8192
  v_add_f32_dpp v20, v20, v20 quad_perm:[2,3,0,1] row_mask:0xf bank_mask:0xf
  v_add_f32_dpp v21, v21, v21 quad_perm:[2,3,0,1] row_mask:0xf bank_mask:0xf
  v_cndmask_b32 v56, v56, v20, s[52:53]
  v_cndmask_b32 v57, v57, v21, s[52:53]
  v_cvt_pk_bf16_f32 v20, v56, v57
  v_lshlrev_b32 v56, 16, v20
  v_and_b32 v57, 0xffff0000, v20
  s_waitcnt vmcnt(4)
  buffer_load_dwordx4 v[244:247], v44, s[32:35], s40 offen nt
  s_add_u32 s40, s40, 8192
  v_mul_f32 v56, s43, v56
  v_mul_f32 v57, s43, v57
  v_cvt_pk_bf16_f32 v20, v56, v57
  v_lshlrev_b32 v42, 16, v20
  v_and_b32 v43, 0xffff0000, v20
  v_max3_f32 v16, v16, v42, v43
  s_sub_u32 s55, s55, 1
  s_cmp_lg_u32 s55, 0
  s_cbranch_scc1 L_kloop
  s_branch L_kloop_x
L_kloop_f:
  s_waitcnt vmcnt(5)
  buffer_load_dwordx4 v[248:251], v44, s[32:35], s40 offen nt
  s_add_u32 s40, s40, 8192
  v_dot2_f32_bf16 v20, v192, v4, 0
  v_dot2_f32_bf16 v21, v196, v4, 0
  v_dot2_f32_bf16 v22, v200, v4, 0
  v_dot2_f32_bf16 v23, v204, v4, 0
  v_dot2_f32_bf16 v20, v193, v5, v20
  v_dot2_f32_bf16 v21, v197, v5, v21
  v_dot2_f32_bf16 v22, v201, v5, v22
  s_waitcnt vmcnt(5)
  buffer_load_dwordx4 v[252:255], v44, s[32:35], s40 offen nt
  s_add_u32 s40, s40, 8192
  v_dot2_f32_bf16 v23, v205, v5, v23
  v_dot2_f32_bf16 v20, v194, v6, v20
  v_dot2_f32_bf16 v21, v198, v6, v21
  v_dot2_f32_bf16 v22, v202, v6, v22
  v_dot2_f32_bf16 v23, v206, v6, v23
  v_dot2_f32_bf16 v20, v195, v7, v20
  v_dot2_f32_bf16 v21, v199, v7, v21
  s_waitcnt vmcnt(5)
  buffer_load_dwordx4 v[128:131], v44, s[32:35], s40 offen nt
  s_add_u32 s40, s40, 8192
  v_dot2_f32_bf16 v22, v203, v7, v22
  v_dot2_f32_bf16 v23, v207, v7, v23
  v_dot2_f32_bf16 v24, v208, v4, 0
  v_dot2_f32_bf16 v25, v212, v4, 0
  v_dot2_f32_bf16 v26, v216, v4, 0
  v_dot2_f32_bf16 v27, v220, v4, 0
  v_dot2_f32_bf16 v24, v209, v5, v24
  s_waitcnt vmcnt(5)
  buffer_load_dwordx4 v[132:135], v44, s[32:35], s40 offen nt
  s_add_u32 s40, s40, 8192
  v_dot2_f32_bf16 v25, v213, v5, v25
  v_dot2_f32_bf16 v26, v217, v5, v26
  v_dot2_f32_bf16 v27, v221, v5, v27
  v_dot2_f32_bf16 v24, v210, v6, v24
  v_dot2_f32_bf16 v25, v214, v6, v25
  v_dot2_f32_bf16 v26, v218, v6, v26
  v_dot2_f32_bf16 v27, v222, v6, v27
  s_waitcnt vmcnt(5)
  buffer_load_dwordx4 v[136:139], v44, s[32:35], s40 offen nt
  s_add_u32 s40, s40, 8192
  v_dot2_f32_bf16 v24, v211, v7, v24
  v_dot2_f32_bf16 v25, v215, v7, v25
  v_dot2_f32_bf16 v26, v219, v7, v26
  v_dot2_f32_bf16 v27, v223, v7, v27
  v_add_f32_dpp v20, v20, v20 row_ror:8 row_mask:0xf bank_mask:0x3
  v_add_f32_dpp v21, v21, v21 row_ror:8 row_mask:0xf bank_mask:0x3
  v_add_f32_dpp v24, v24, v24 row_ror:8 row_mask:0xf bank_mask:0x3
  s_waitcnt vmcnt(5)
  buffer_load_dwordx4 v[140:143], v44, s[32:35], s40 offen nt
  s_add_u32 s40, s40, 8192
  v_add_f32_dpp v25, v25, v25 row_ror:8 row_mask:0xf bank_mask:0x3
  v_add_f32_dpp v20, v22, v22 row_ror:8 row_mask:0xf bank_mask:0xc
  v_add_f32_dpp v21, v23, v23 row_ror:8 row_mask:0xf bank_mask:0xc
  v_add_f32_dpp v24, v26, v26 row_ror:8 row_mask:0xf bank_mask:0xc
  v_add_f32_dpp v25, v27, v27 row_ror:8 row_mask:0xf bank_mask:0xc
  v_add_f32_dpp v20, v20, v20 row_half_mirror row_mask:0xf bank_mask:0x5
  v_mov_b32 v28, v30
  s_waitcnt vmcnt(5)
  buffer_load_dwordx4 v[144:147], v44, s[32:35], s40 offen nt
  s_add_u32 s40, s40, 8192
  v_add_f32_dpp v21, v21, v21 row_half_mirror row_mask:0xf bank_mask:0x5
  v_mov_b32 v29, v31
  v_add_f32_dpp v20, v24, v24 row_half_mirror row_mask:0xf bank_mask:0xa
  v_mov_b32 v30, v32
  v_add_f32_dpp v21, v25, v25 row_half_mirror row_mask:0xf bank_mask:0xa
  v_mov_b32 v31, v33
  v_add_f32_dpp v20, v20, v20 quad_perm:[1,0,3,2] row_mask:0xf bank_mask:0xf
  s_waitcnt vmcnt(5)
  buffer_load_dwordx4 v[148:151], v44, s[32:35], s40 offen nt
  s_add_u32 s40, s40, 8192
  v_mov_b32 v32, v34
  v_add_f32_dpp v21, v21, v21 quad_perm:[1,0,3,2] row_mask:0xf bank_mask:0xf
  v_mov_b32 v33, v35
  v_add_f32_dpp v56, v20, v20 quad_perm:[2,3,0,1] row_mask:0xf bank_mask:0xf
  v_mov_b32 v34, v36
  v_add_f32_dpp v57, v21, v21 quad_perm:[2,3,0,1] row_mask:0xf bank_mask:0xf
  v_dot2_f32_bf16 v20, v224, v4, 0
  s_waitcnt vmcnt(5)
  buffer_load_dwordx4 v[152:155], v44, s[32:35], s40 offen nt
  s_add_u32 s40, s40, 8192
  v_dot2_f32_bf16 v21, v228, v4, 0
  v_dot2_f32_bf16 v22, v232, v4, 0
  v_dot2_f32_bf16 v23, v236, v4, 0
  v_dot2_f32_bf16 v20, v225, v5, v20
  v_dot2_f32_bf16 v21, v229, v5, v21
  v_dot2_f32_bf16 v22, v233, v5, v22
  v_dot2_f32_bf16 v23, v237, v5, v23
  s_waitcnt vmcnt(5)
  buffer_load_dwordx4 v[156:159], v44, s[32:35], s40 offen nt
  s_add_u32 s40, s40, 8192
  v_dot2_f32_bf16 v20, v226, v6, v20
  v_dot2_f32_bf16 v21, v230, v6, v21
  v_dot2_f32_bf16 v22, v234, v6, v22
  v_dot2_f32_bf16 v23, v238, v6, v23
  v_dot2_f32_bf16 v20, v227, v7, v20
  v_dot2_f32_bf16 v21, v231, v7, v21
  v_dot2_f32_bf16 v22, v235, v7, v22
  s_waitcnt vmcnt(5)
  buffer_load_dwordx4 v[160:163], v44, s[32:35], s40 offen nt
  s_add_u32 s40, s40, 8192
  v_dot2_f32_bf16 v23, v239, v7, v23
  v_dot2_f32_bf16 v24, v240, v4, 0
  v_dot2_f32_bf16 v25, v244, v4, 0
  v_dot2_f32_bf16 v26, v248, v4, 0
  v_dot2_f32_bf16 v27, v252, v4, 0
  v_dot2_f32_bf16 v24, v241, v5, v24
  s_waitcnt vmcnt(5)
  buffer_load_dwordx4 v[164:167], v44, s[32:35], s40 offen nt
  s_add_u32 s40, s40, 8192
  v_dot2_f32_bf16 v25, v245, v5, v25
  v_dot2_f32_bf16 v26, v249, v5, v26
  v_dot2_f32_bf16 v27, v253, v5, v27
  v_dot2_f32_bf16 v24, v242, v6, v24
  v_dot2_f32_bf16 v25, v246, v6, v25
  v_dot2_f32_bf16 v26, v250, v6, v26
  v_dot2_f32_bf16 v27, v254, v6, v27
  s_waitcnt vmcnt(5)
  buffer_load_dwordx4 v[168:171], v44, s[32:35], s40 offen nt
  s_add_u32 s40, s40, 8192
  v_dot2_f32_bf16 v24, v243, v7, v24
  v_dot2_f32_bf16 v25, v247, v7, v25
  v_dot2_f32_bf16 v26, v251, v7, v26
  v_dot2_f32_bf16 v27, v255, v7, v27
  v_add_f32_dpp v20, v20, v20 row_ror:8 row_mask:0xf bank_mask:0x3
  v_add_f32_dpp v21, v21, v21 row_ror:8 row_mask:0xf bank_mask:0x3
  v_add_f32_dpp v24, v24, v24 row_ror:8 row_mask:0xf bank_mask:0x3
  s_waitcnt vmcnt(5)
  buffer_load_dwordx4 v[172:175], v44, s[32:35], s40 offen nt
  s_add_u32 s40, s40, 8192
  v_add_f32_dpp v25, v25, v25 row_ror:8 row_mask:0xf bank_mask:0x3
  v_add_f32_dpp v20, v22, v22 row_ror:8 row_mask:0xf bank_mask:0xc
  v_add_f32_dpp v21, v23, v23 row_ror:8 row_mask:0xf bank_mask:0xc
  v_add_f32_dpp v24, v26, v26 row_ror:8 row_mask:0xf bank_mask:0xc
  v_add_f32_dpp v25, v27, v27 row_ror:8 row_mask:0xf bank_mask:0xc
  v_add_f32_dpp v20, v20, v20 row_half_mirror row_mask:0xf bank_mask:0x5
  v_mov_b32 v35, v37
  s_waitcnt vmcnt(5)
  buffer_load_dwordx4 v[176:179], v44, s[32:35], s40 offen nt
  s_add_u32 s40, s40, 8192
  v_add_f32_dpp v21, v21, v21 row_half_mirror row_mask:0xf bank_mask:0x5
  v_mov_b32 v36, v38
  v_add_f32_dpp v20, v24, v24 row_half_mirror row_mask:0xf bank_mask:0xa
  v_mov_b32 v37, v39
  v_add_f32_dpp v21, v25, v25 row_half_mirror row_mask:0xf bank_mask:0xa
  v_mov_b32 v38, v40
  v_add_f32_dpp v20, v20, v20 quad_perm:[1,0,3,2] row_mask:0xf bank_mask:0xf
  s_waitcnt vmcnt(5)
  buffer_load_dwordx4 v[180:183], v44, s[32:35], s40 offen nt
  s_add_u32 s40, s40, 8192
  v_mov_b32 v39, v41
  v_add_f32_dpp v21, v21, v21 quad_perm:[1,0,3,2] row_mask:0xf bank_mask:0xf
  v_mov_b32 v40, v42
  v_add_f32_dpp v20, v20, v20 quad_perm:[2,3,0,1] row_mask:0xf bank_mask:0xf
  v_mov_b32 v41, v43
  v_add_f32_dpp v21, v21, v21 quad_perm:[2,3,0,1] row_mask:0xf bank_mask:0xf
  v_cndmask_b32 v56, v56, v20, s[48:49]
  v_add_u32 v58, 1, v58
  ds_write_b32 v59, v58 offset:27008
  s_waitcnt vmcnt(5)
  buffer_load_dwordx4 v[184:187], v44, s[32:35], s40 offen nt
  s_add_u32 s40, s40, 8192
  v_cndmask_b32 v57, v57, v21, s[48:49]
  v_dot2_f32_bf16 v20, v128, v4, 0
  v_dot2_f32_bf16 v21, v132, v4, 0
  v_dot2_f32_bf16 v22, v136, v4, 0
  v_dot2_f32_bf16 v23, v140, v4, 0
  v_dot2_f32_bf16 v20, v129, v5, v20
  v_dot2_f32_bf16 v21, v133, v5, v21
  s_waitcnt vmcnt(5)
  buffer_load_dwordx4 v[188:191], v44, s[32:35], s40 offen nt
  s_add_u32 s40, s40, 8192
  v_dot2_f32_bf16 v22, v137, v5, v22
  v_dot2_f32_bf16 v23, v141, v5, v23
  v_dot2_f32_bf16 v20, v130, v6, v20
  v_dot2_f32_bf16 v21, v134, v6, v21
  v_dot2_f32_bf16 v22, v138, v6, v22
  v_dot2_f32_bf16 v23, v142, v6, v23
  v_dot2_f32_bf16 v20, v131, v7, v20
  s_cmp_eq_u32 s55, 1
  s_cselect_b32 s32, s36, s32
  s_cselect_b32 s33, s37, s33
  s_cselect_b32 s40, 0, s40
  s_waitcnt vmcnt(5)
  buffer_load_dwordx4 v[192:195], v44, s[32:35], s40 offen nt
  s_add_u32 s40, s40, 8192
  v_dot2_f32_bf16 v21, v135, v7, v21
  v_dot2_f32_bf16 v22, v139, v7, v22
  v_dot2_f32_bf16 v23, v143, v7, v23
  v_dot2_f32_bf16 v24, v144, v4, 0
  v_dot2_f32_bf16 v25, v148, v4, 0
  v_dot2_f32_bf16 v26, v152, v4, 0
  v_dot2_f32_bf16 v27, v156, v4, 0
  s_waitcnt vmcnt(5)
  buffer_load_dwordx4 v[196:199], v44, s[32:35], s40 offen nt
  s_add_u32 s40, s40, 8192
  v_dot2_f32_bf16 v24, v145, v5, v24
  v_dot2_f32_bf16 v25, v149, v5, v25
  v_dot2_f32_bf16 v26, v153, v5, v26
  v_dot2_f32_bf16 v27, v157, v5, v27
  v_dot2_f32_bf16 v24, v146, v6, v24
  v_dot2_f32_bf16 v25, v150, v6, v25
  v_dot2_f32_bf16 v26, v154, v6, v26
  s_waitcnt vmcnt(5)
  buffer_load_dwordx4 v[200:203], v44, s[32:35], s40 offen nt
  s_add_u32 s40, s40, 8192
  v_dot2_f32_bf16 v27, v158, v6, v27
  v_dot2_f32_bf16 v24, v147, v7, v24
  v_dot2_f32_bf16 v25, v151, v7, v25
  v_dot2_f32_bf16 v26, v155, v7, v26
  v_dot2_f32_bf16 v27, v159, v7, v27
  v_add_f32_dpp v20, v20, v20 row_ror:8 row_mask:0xf bank_mask:0x3
  v_add_f32_dpp v21, v21, v21 row_ror:8 row_mask:0xf bank_mask:0x3
  s_waitcnt vmcnt(5)
  buffer_load_dwordx4 v[204:207], v44, s[32:35], s40 offen nt
  s_add_u32 s40, s40, 8192
  v_add_f32_dpp v24, v24, v24 row_ror:8 row_mask:0xf bank_mask:0x3
  v_add_f32_dpp v25, v25, v25 row_ror:8 row_mask:0xf bank_mask:0x3
  v_add_f32_dpp v20, v22, v22 row_ror:8 row_mask:0xf bank_mask:0xc
  v_add_f32_dpp v21, v23, v23 row_ror:8 row_mask:0xf bank_mask:0xc
  v_add_f32_dpp v24, v26, v26 row_ror:8 row_mask:0xf bank_mask:0xc
  v_add_f32_dpp v25, v27, v27 row_ror:8 row_mask:0xf bank_mask:0xc
  s_waitcnt vmcnt(5)
  buffer_load_dwordx4 v[208:211], v44, s[32:35], s40 offen nt
  s_add_u32 s40, s40, 8192
  v_add_f32_dpp v20, v20, v20 row_half_mirror row_mask:0xf bank_mask:0x5
  v_add_f32_dpp v21, v21, v21 row_half_mirror row_mask:0xf bank_mask:0x5
  s_nop 0
  v_add_f32_dpp v20, v24, v24 row_half_mirror row_mask:0xf bank_mask:0xa
  v_add_f32_dpp v21, v25, v25 row_half_mirror row_mask:0xf bank_mask:0xa
  s_nop 0
  v_add_f32_dpp v20, v20, v20 quad_perm:[1,0,3,2] row_mask:0xf bank_mask:0xf
  v_add_f32_dpp v21, v21, v21 quad_perm:[1,0,3,2] row_mask:0xf bank_mask:0xf
  s_nop 0
  v_add_f32_dpp v20, v20, v20 quad_perm:[2,3,0,1] row_mask:0xf bank_mask:0xf
  s_waitcnt vmcnt(5)
  buffer_load_dwordx4 v[212:215], v44, s[32:35], s40 offen nt
  s_add_u32 s40, s40, 8192
  v_add_f32_dpp v21, v21, v21 quad_perm:[2,3,0,1] row_mask:0xf bank_mask:0xf
  v_cndmask_b32 v56, v56, v20, s[50:51]
  v_cndmask_b32 v57, v57, v21, s[50:51]
  v_dot2_f32_bf16 v20, v160, v4, 0
  v_dot2_f32_bf16 v21, v164, v4, 0
  v_dot2_f32_bf16 v22, v168, v4, 0
  v_dot2_f32_bf16 v23, v172, v4, 0
  s_waitcnt vmcnt(5)
  buffer_load_dwordx4 v[216:219], v44, s[32:35], s40 offen nt
  s_add_u32 s40, s40, 8192
  v_dot2_f32_bf16 v20, v161, v5, v20
  v_dot2_f32_bf16 v21, v165, v5, v21
  v_dot2_f32_bf16 v22, v169, v5, v22
  v_dot2_f32_bf16 v23, v173, v5, v23
  v_dot2_f32_bf16 v20, v162, v6, v20
  v_dot2_f32_bf16 v21, v166, v6, v21
  v_dot2_f32_bf16 v22, v170, v6, v22
  s_waitcnt vmcnt(5)
  buffer_load_dwordx4 v[220:223], v44, s[32:35], s40 offen nt
  s_add_u32 s40, s40, 8192
  v_dot2_f32_bf16 v23, v174, v6, v23
  v_dot2_f32_bf16 v20, v163, v7, v20
  v_dot2_f32_bf16 v21, v167, v7, v21
  v_dot2_f32_bf16 v22, v171, v7, v22
  v_dot2_f32_bf16 v23, v175, v7, v23
  v_dot2_f32_bf16 v24, v176, v4, 0
  v_dot2_f32_bf16 v25, v180, v4, 0
  s_waitcnt vmcnt(5)
  buffer_load_dwordx4 v[224:227], v44, s[32:35], s40 offen nt
  s_add_u32 s40, s40, 8192
  v_dot2_f32_bf16 v26, v184, v4, 0
  v_dot2_f32_bf16 v27, v188, v4, 0
  v_dot2_f32_bf16 v24, v177, v5, v24
  v_dot2_f32_bf16 v25, v181, v5, v25
  v_dot2_f32_bf16 v26, v185, v5, v26
  v_dot2_f32_bf16 v27, v189, v5, v27
  v_dot2_f32_bf16 v24, v178, v6, v24
  s_waitcnt vmcnt(5)
  buffer_load_dwordx4 v[228:231], v44, s[32:35], s40 offen nt
  s_add_u32 s40, s40, 8192
  v_dot2_f32_bf16 v25, v182, v6, v25
  v_dot2_f32_bf16 v26, v186, v6, v26
  v_dot2_f32_bf16 v27, v190, v6, v27
  v_dot2_f32_bf16 v24, v179, v7, v24
  v_dot2_f32_bf16 v25, v183, v7, v25
  v_dot2_f32_bf16 v26, v187, v7, v26
  v_dot2_f32_bf16 v27, v191, v7, v27
  s_waitcnt vmcnt(5)
  buffer_load_dwordx4 v[232:235], v44, s[32:35], s40 offen nt
  s_add_u32 s40, s40, 8192
  v_add_f32_dpp v20, v20, v20 row_ror:8 row_mask:0xf bank_mask:0x3
  v_add_f32_dpp v21, v21, v21 row_ror:8 row_mask:0xf bank_mask:0x3
  v_add_f32_dpp v24, v24, v24 row_ror:8 row_mask:0xf bank_mask:0x3
  v_add_f32_dpp v25, v25, v25 row_ror:8 row_mask:0xf bank_mask:0x3
  v_add_f32_dpp v20, v22, v22 row_ror:8 row_mask:0xf bank_mask:0xc
  v_add_f32_dpp v21, v23, v23 row_ror:8 row_mask:0xf bank_mask:0xc
  v_add_f32_dpp v24, v26, v26 row_ror:8 row_mask:0xf bank_mask:0xc
  ds_read_b32 v61, v62 offset:27024
  s_waitcnt vmcnt(5)
  buffer_load_dwordx4 v[236:239], v44, s[32:35], s40 offen nt
  s_add_u32 s40, s40, 8192
  v_add_f32_dpp v25, v27, v27 row_ror:8 row_mask:0xf bank_mask:0xc
  v_add_f32_dpp v20, v20, v20 row_half_mirror row_mask:0xf bank_mask:0x5
  v_add_f32_dpp v21, v21, v21 row_half_mirror row_mask:0xf bank_mask:0x5
  s_nop 0
  v_add_f32_dpp v20, v24, v24 row_half_mirror row_mask:0xf bank_mask:0xa
  v_add_f32_dpp v21, v25, v25 row_half_mirror row_mask:0xf bank_mask:0xa
  s_nop 0
  v_add_f32_dpp v20, v20, v20 quad_perm:[1,0,3,2] row_mask:0xf bank_mask:0xf
  v_add_f32_dpp v21, v21, v21 quad_perm:[1,0,3,2] row_mask:0xf bank_mask:0xf
  s_waitcnt vmcnt(5)
  buffer_load_dwordx4 v[240:243], v44, s[32:35], s40 offen nt
  s_add_u32 s40, s40, 8192
  v_add_f32_dpp v20, v20, v20 quad_perm:[2,3,0,1] row_mask:0xf bank_mask:0xf
  v_add_f32_dpp v21, v21, v21 quad_perm:[2,3,0,1] row_mask:0xf bank_mask:0xf
  v_cndmask_b32 v56, v56, v20, s[52:53]
  v_cndmask_b32 v57, v57, v21, s[52:53]
  v_cvt_pk_bf16_f32 v20, v56, v57
  v_lshlrev_b32 v56, 16, v20
  v_and_b32 v57, 0xffff0000, v20
  s_waitcnt vmcnt(5)
  buffer_load_dwordx4 v[244:247], v44, s[32:35], s40 offen nt
  s_add_u32 s40, s40, 8192
  v_mul_f32 v56, s43, v56
  v_mul_f32 v57, s43, v57
  v_cvt_pk_bf16_f32 v20, v56, v57
  v_lshlrev_b32 v42, 16, v20
  v_and_b32 v43, 0xffff0000, v20
  v_max3_f32 v16, v16, v42, v43
  s_sub_u32 s55, s55, 1
  s_cmp_lg_u32 s55, 0
  s_cbranch_scc1 L_kloop
L_kloop_x:
  s_waitcnt vmcnt(4)
  buffer_load_dwordx4 v[248:251], v44, s[32:35], s40 offen nt
  s_add_u32 s40, s40, 8192
  v_max_f32_dpp v16, v16, v16 row_ror:8 row_mask:0xf bank_mask:0xf
  s_nop 1
  v_max_f32_dpp v16, v16, v16 row_ror:4 row_mask:0xf bank_mask:0xf
  s_nop 1
  v_max_f32_dpp v16, v16, v16 row_ror:2 row_mask:0xf bank_mask:0xf
  s_nop 1
  v_max_f32_dpp v16, v16, v16 row_ror:1 row_mask:0xf bank_mask:0xf
  v_mul_f32 v17, s44, v16
  v_fma_f32 v28, v28, s44, -v17
  v_fma_f32 v29, v29, s44, -v17
  v_fma_f32 v30, v30, s44, -v17
  v_fma_f32 v31, v31, s44, -v17
  v_fma_f32 v32, v32, s44, -v17
  v_fma_f32 v33, v33, s44, -v17
  v_fma_f32 v34, v34, s44, -v17
  v_fma_f32 v35, v35, s44, -v17
  v_fma_f32 v36, v36, s44, -v17
  v_fma_f32 v37, v37, s44, -v17
  v_fma_f32 v38, v38, s44, -v17
  v_fma_f32 v39, v39, s44, -v17
  v_fma_f32 v40, v40, s44, -v17
  v_fma_f32 v41, v41, s44, -v17
  v_fma_f32 v42, v42, s44, -v17
  v_fma_f32 v43, v43, s44, -v17
  v_exp_f32 v28, v28
  v_exp_f32 v29, v29
  v_exp_f32 v30, v30
  v_exp_f32 v31, v31
  v_exp_f32 v32, v32
  v_exp_f32 v33, v33
  v_exp_f32 v34, v34
  s_waitcnt vmcnt(4)
  buffer_load_dwordx4 v[252:255], v44, s[32:35], s40 offen nt
  s_add_u32 s40, s40, 8192
  v_exp_f32 v35, v35
  v_exp_f32 v36, v36
  v_exp_f32 v37, v37
  v_exp_f32 v38, v38
  v_exp_f32 v39, v39
  v_exp_f32 v40, v40
  v_exp_f32 v41, v41
  v_exp_f32 v42, v42
  v_exp_f32 v43, v43
  v_cvt_pk_bf16_f32 v48, v28, v29
  v_cvt_pk_bf16_f32 v49, v30, v31
  v_cvt_pk_bf16_f32 v50, v32, v33
  v_cvt_pk_bf16_f32 v51, v34, v35
  v_cvt_pk_bf16_f32 v52, v36, v37
  v_cvt_pk_bf16_f32 v53, v38, v39
  v_cvt_pk_bf16_f32 v54, v40, v41
  v_cvt_pk_bf16_f32 v55, v42, v43
  v_add_f32 v28, v28, v36
  v_add_f32 v29, v29, v37
  v_add_f32 v30, v30, v38
  v_add_f32 v31, v31, v39
  v_add_f32 v32, v32, v40
  v_add_f32 v33, v33, v41
  v_add_f32 v34, v34, v42
  v_add_f32 v35, v35, v43
  v_add_f32 v28, v28, v32
  v_add_f32 v29, v29, v33
  s_waitcnt vmcnt(4)
  buffer_load_dwordx4 v[128:131], v44, s[32:35], s40 offen nt
  s_add_u32 s40, s40, 8192
  v_add_f32 v30, v30, v34
  v_add_f32 v31, v31, v35
  v_add_f32 v28, v28, v30
  v_add_f32 v29, v29, v31
  v_add_f32 v28, v28, v29
  s_nop 1
  v_add_f32_dpp v28, v28, v28 row_ror:8 row_mask:0xf bank_mask:0xf
  s_nop 1
  v_add_f32_dpp v28, v28, v28 row_ror:4 row_mask:0xf bank_mask:0xf
  s_nop 1
  v_add_f32_dpp v28, v28, v28 row_ror:2 row_mask:0xf bank_mask:0xf
  s_nop 1
  v_add_f32_dpp v28, v28, v28 row_ror:1 row_mask:0xf bank_mask:0xf
  ds_write_b32 v47, v17 offset:26880
  ds_write_b32 v47, v28 offset:26944
  s_add_u32 s61, s61, 0x9e3779b9
  s_and_b32 s94, s61, 0xff
  s_bfe_u32 s95, s61, 0x80008
  s_bfe_u32 s96, s61, 0x80010
  s_lshr_b32 s97, s61, 24
  s_mov_b32 s36, s26
  s_mov_b32 s37, s27
  s_mov_b32 s38, 2097152
  s_mov_b32 s39, 0x20000
  s_mov_b32 s80, s22
  s_mov_b32 s81, s23
  s_mov_b32 s82, 5120
  s_mov_b32 s83, 0x20000
  s_mul_i32 s91, s89, 10
  s_add_u32 s91, s91, s31
  s_sub_u32 s91, s91, 22
  s_and_b32 s92, s91, 3
  s_waitcnt vmcnt(4)
  buffer_load_dwordx4 v[132:135], v44, s[32:35], s40 offen nt
  s_add_u32 s40, s40, 8192
  s_lshr_b32 s87, s91, 2
  s_mul_i32 s72, s92, 163840
  s_lshl_b32 s93, s87, 7
  s_add_u32 s72, s72, s93
  s_add_u32 s72, s72, 65536
  s_mul_i32 s92, s92, 1280
  s_lshl_b32 s63, s87, 6
  s_add_u32 s63, s63, s92
  v_lshrrev_b32 v64, 3, v1
  v_mul_u32_u24 v64, 2560, v64
  v_and_b32 v66, 7, v1
  v_lshl_add_u32 v64, v66, 4, v64
  v_lshlrev_b32 v65, 3, v66
  v_lshl_add_u32 v65, v2, 1, v65
  v_and_b32 v66, 8, v1
  v_mov_b32 v67, 2147483648
  v_cmp_eq_u32 vcc, 0, v66
  s_nop 1
  v_cndmask_b32 v65, v67, v65, vcc
  v_lshlrev_b32 v66, 3, v1
  s_cmp_ge_u32 s31, 22
  s_cselect_b32 s88, s3, 0
  s_add_u32 s73, s72, 20480
  s_add_u32 s74, s72, 40960
  s_add_u32 s75, s72, 61440
  s_add_u32 s76, s72, 81920
  s_add_u32 s77, s72, 102400
  s_add_u32 s78, s72, 122880
  s_add_u32 s79, s72, 143360
  s_mov_b32 s55, 6
L_vloop:
  s_waitcnt lgkmcnt(0)
  v_readfirstlane_b32 s56, v61
  s_nop 0
  s_cmp_lg_u32 s56, 0
  s_nop 1
  s_cbranch_scc1 L_vloop_f
  s_waitcnt vmcnt(4)
  buffer_load_dwordx4 v[136:139], v44, s[32:35], s40 offen nt
  s_add_u32 s40, s40, 8192
  v_perm_b32 v20, v196, v192, s41
  v_perm_b32 v21, v196, v192, s42
  v_perm_b32 v22, v197, v193, s41
  v_perm_b32 v23, v197, v193, s42
  v_perm_b32 v24, v198, v194, s41
  v_perm_b32 v25, v198, v194, s42
  v_perm_b32 v26, v199, v195, s41
  v_perm_b32 v27, v199, v195, s42
  v_dot2c_f32_bf16_dpp v8, v48, v20 row_newbcast:0 row_mask:0xf bank_mask:0xf
  s_waitcnt vmcnt(4)
  buffer_load_dwordx4 v[140:143], v44, s[32:35], s40 offen nt
  s_add_u32 s40, s40, 8192
  v_dot2c_f32_bf16_dpp v9, v48, v21 row_newbcast:0 row_mask:0xf bank_mask:0xf
  v_dot2c_f32_bf16_dpp v10, v48, v22 row_newbcast:0 row_mask:0xf bank_mask:0xf
  v_dot2c_f32_bf16_dpp v11, v48, v23 row_newbcast:0 row_mask:0xf bank_mask:0xf
  v_dot2c_f32_bf16_dpp v12, v48, v24 row_newbcast:0 row_mask:0xf bank_mask:0xf
  v_dot2c_f32_bf16_dpp v13, v48, v25 row_newbcast:0 row_mask:0xf bank_mask:0xf
  v_dot2c_f32_bf16_dpp v14, v48, v26 row_newbcast:0 row_mask:0xf bank_mask:0xf
  v_dot2c_f32_bf16_dpp v15, v48, v27 row_newbcast:0 row_mask:0xf bank_mask:0xf
  v_perm_b32 v20, v204, v200, s41
  s_waitcnt vmcnt(4)
  buffer_load_dwordx4 v[144:147], v44, s[32:35], s40 offen nt
  s_add_u32 s40, s40, 8192
  v_perm_b32 v21, v204, v200, s42
  v_perm_b32 v22, v205, v201, s41
  v_perm_b32 v23, v205, v201, s42
  v_perm_b32 v24, v206, v202, s41
  v_perm_b32 v25, v206, v202, s42
  v_perm_b32 v26, v207, v203, s41
  v_perm_b32 v27, v207, v203, s42
  v_dot2c_f32_bf16_dpp v8, v48, v20 row_newbcast:8 row_mask:0xf bank_mask:0xf
  s_waitcnt vmcnt(4)
  buffer_load_dwordx4 v[148:151], v44, s[32:35], s40 offen nt
  s_add_u32 s40, s40, 8192
  v_dot2c_f32_bf16_dpp v9, v48, v21 row_newbcast:8 row_mask:0xf bank_mask:0xf
  v_dot2c_f32_bf16_dpp v10, v48, v22 row_newbcast:8 row_mask:0xf bank_mask:0xf
  v_dot2c_f32_bf16_dpp v11, v48, v23 row_newbcast:8 row_mask:0xf bank_mask:0xf
  v_dot2c_f32_bf16_dpp v12, v48, v24 row_newbcast:8 row_mask:0xf bank_mask:0xf
  v_dot2c_f32_bf16_dpp v13, v48, v25 row_newbcast:8 row_mask:0xf bank_mask:0xf
  v_dot2c_f32_bf16_dpp v14, v48, v26 row_newbcast:8 row_mask:0xf bank_mask:0xf
  v_dot2c_f32_bf16_dpp v15, v48, v27 row_newbcast:8 row_mask:0xf bank_mask:0xf
  v_perm_b32 v20, v212, v208, s41
  s_waitcnt vmcnt(4)
  buffer_load_dwordx4 v[152:155], v44, s[32:35], s40 offen nt
  s_add_u32 s40, s40, 8192
  v_perm_b32 v21, v212, v208, s42
  v_perm_b32 v22, v213, v209, s41
  v_perm_b32 v23, v213, v209, s42
  v_perm_b32 v24, v214, v210, s41
  v_perm_b32 v25, v214, v210, s42
  v_perm_b32 v26, v215, v211, s41
  v_perm_b32 v27, v215, v211, s42
  v_dot2c_f32_bf16_dpp v8, v48, v20 row_newbcast:4 row_mask:0xf bank_mask:0xf
  v_dot2c_f32_bf16_dpp v9, v48, v21 row_newbcast:4 row_mask:0xf bank_mask:0xf
  s_waitcnt vmcnt(4)
  buffer_load_dwordx4 v[156:159], v44, s[32:35], s40 offen nt
  s_add_u32 s40, s40, 8192
  v_dot2c_f32_bf16_dpp v10, v48, v22 row_newbcast:4 row_mask:0xf bank_mask:0xf
  v_dot2c_f32_bf16_dpp v11, v48, v23 row_newbcast:4 row_mask:0xf bank_mask:0xf
  v_dot2c_f32_bf16_dpp v12, v48, v24 row_newbcast:4 row_mask:0xf bank_mask:0xf
  v_dot2c_f32_bf16_dpp v13, v48, v25 row_newbcast:4 row_mask:0xf bank_mask:0xf
  v_dot2c_f32_bf16_dpp v14, v48, v26 row_newbcast:4 row_mask:0xf bank_mask:0xf
  v_dot2c_f32_bf16_dpp v15, v48, v27 row_newbcast:4 row_mask:0xf bank_mask:0xf
  v_perm_b32 v20, v220, v216, s41
  v_perm_b32 v21, v220, v216, s42
  s_waitcnt vmcnt(4)
  buffer_load_dwordx4 v[160:163], v44, s[32:35], s40 offen nt
  s_add_u32 s40, s40, 8192
  v_perm_b32 v22, v221, v217, s41
  v_perm_b32 v23, v221, v217, s42
  v_perm_b32 v24, v222, v218, s41
  v_perm_b32 v25, v222, v218, s42
  v_perm_b32 v26, v223, v219, s41
  v_perm_b32 v27, v223, v219, s42
  v_dot2c_f32_bf16_dpp v8, v48, v20 row_newbcast:12 row_mask:0xf bank_mask:0xf
  v_dot2c_f32_bf16_dpp v9, v48, v21 row_newbcast:12 row_mask:0xf bank_mask:0xf
  s_waitcnt vmcnt(4)
  buffer_load_dwordx4 v[164:167], v44, s[32:35], s40 offen nt
  s_add_u32 s40, s40, 8192
  v_dot2c_f32_bf16_dpp v10, v48, v22 row_newbcast:12 row_mask:0xf bank_mask:0xf
  v_dot2c_f32_bf16_dpp v11, v48, v23 row_newbcast:12 row_mask:0xf bank_mask:0xf
  v_dot2c_f32_bf16_dpp v12, v48, v24 row_newbcast:12 row_mask:0xf bank_mask:0xf
  v_dot2c_f32_bf16_dpp v13, v48, v25 row_newbcast:12 row_mask:0xf bank_mask:0xf
  v_dot2c_f32_bf16_dpp v14, v48, v26 row_newbcast:12 row_mask:0xf bank_mask:0xf
  v_dot2c_f32_bf16_dpp v15, v48, v27 row_newbcast:12 row_mask:0xf bank_mask:0xf
  v_perm_b32 v20, v228, v224, s41
  v_perm_b32 v21, v228, v224, s42
  s_waitcnt vmcnt(4)
  buffer_load_dwordx4 v[168:171], v44, s[32:35], s40 offen nt
  s_add_u32 s40, s40, 8192
  v_perm_b32 v22, v229, v225, s41
  v_perm_b32 v23, v229, v225, s42
  v_perm_b32 v24, v230, v226, s41
  v_perm_b32 v25, v230, v226, s42
  v_perm_b32 v26, v231, v227, s41
  v_perm_b32 v27, v231, v227, s42
  v_dot2c_f32_bf16_dpp v8, v48, v20 row_newbcast:1 row_mask:0xf bank_mask:0xf
  v_dot2c_f32_bf16_dpp v9, v48, v21 row_newbcast:1 row_mask:0xf bank_mask:0xf
  s_waitcnt vmcnt(4)
  buffer_load_dwordx4 v[172:175], v44, s[32:35], s40 offen nt
  s_add_u32 s40, s40, 8192
  v_dot2c_f32_bf16_dpp v10, v48, v22 row_newbcast:1 row_mask:0xf bank_mask:0xf
  v_dot2c_f32_bf16_dpp v11, v48, v23 row_newbcast:1 row_mask:0xf bank_mask:0xf
  v_dot2c_f32_bf16_dpp v12, v48, v24 row_newbcast:1 row_mask:0xf bank_mask:0xf
  v_dot2c_f32_bf16_dpp v13, v48, v25 row_newbcast:1 row_mask:0xf bank_mask:0xf
  v_dot2c_f32_bf16_dpp v14, v48, v26 row_newbcast:1 row_mask:0xf bank_mask:0xf
  v_dot2c_f32_bf16_dpp v15, v48, v27 row_newbcast:1 row_mask:0xf bank_mask:0xf
  v_perm_b32 v20, v236, v232, s41
  v_perm_b32 v21, v236, v232, s42
  v_perm_b32 v22, v237, v233, s41
  s_waitcnt vmcnt(4)
  buffer_load_dwordx4 v[176:179], v44, s[32:35], s40 offen nt
  s_add_u32 s40, s40, 8192
  v_perm_b32 v23, v237, v233, s42
  v_perm_b32 v24, v238, v234, s41
  v_perm_b32 v25, v238, v234, s42
  v_perm_b32 v26, v239, v235, s41
  v_perm_b32 v27, v239, v235, s42
  v_dot2c_f32_bf16_dpp v8, v48, v20 row_newbcast:9 row_mask:0xf bank_mask:0xf
  v_dot2c_f32_bf16_dpp v9, v48, v21 row_newbcast:9 row_mask:0xf bank_mask:0xf
  v_dot2c_f32_bf16_dpp v10, v48, v22 row_newbcast:9 row_mask:0xf bank_mask:0xf
  s_waitcnt vmcnt(4)
  buffer_load_dwordx4 v[180:183], v44, s[32:35], s40 offen nt
  s_add_u32 s40, s40, 8192
  v_dot2c_f32_bf16_dpp v11, v48, v23 row_newbcast:9 row_mask:0xf bank_mask:0xf
  v_dot2c_f32_bf16_dpp v12, v48, v24 row_newbcast:9 row_mask:0xf bank_mask:0xf
  v_dot2c_f32_bf16_dpp v13, v48, v25 row_newbcast:9 row_mask:0xf bank_mask:0xf
  v_dot2c_f32_bf16_dpp v14, v48, v26 row_newbcast:9 row_mask:0xf bank_mask:0xf
  v_dot2c_f32_bf16_dpp v15, v48, v27 row_newbcast:9 row_mask:0xf bank_mask:0xf
  v_perm_b32 v20, v244, v240, s41
  v_perm_b32 v21, v244, v240, s42
  v_perm_b32 v22, v245, v241, s41
  s_waitcnt vmcnt(4)
  buffer_load_dwordx4 v[184:187], v44, s[32:35], s40 offen nt
  s_add_u32 s40, s40, 8192
  v_perm_b32 v23, v245, v241, s42
  v_perm_b32 v24, v246, v242, s41
  v_perm_b32 v25, v246, v242, s42
  v_perm_b32 v26, v247, v243, s41
  v_perm_b32 v27, v247, v243, s42
  v_dot2c_f32_bf16_dpp v8, v48, v20 row_newbcast:5 row_mask:0xf bank_mask:0xf
  v_dot2c_f32_bf16_dpp v9, v48, v21 row_newbcast:5 row_mask:0xf bank_mask:0xf
  v_dot2c_f32_bf16_dpp v10, v48, v22 row_newbcast:5 row_mask:0xf bank_mask:0xf
  s_waitcnt vmcnt(4)
  buffer_load_dwordx4 v[188:191], v44, s[32:35], s40 offen nt
  s_add_u32 s40, s40, 8192
  v_dot2c_f32_bf16_dpp v11, v48, v23 row_newbcast:5 row_mask:0xf bank_mask:0xf
  v_dot2c_f32_bf16_dpp v12, v48, v24 row_newbcast:5 row_mask:0xf bank_mask:0xf
  v_dot2c_f32_bf16_dpp v13, v48, v25 row_newbcast:5 row_mask:0xf bank_mask:0xf
  v_dot2c_f32_bf16_dpp v14, v48, v26 row_newbcast:5 row_mask:0xf bank_mask:0xf
  v_dot2c_f32_bf16_dpp v15, v48, v27 row_newbcast:5 row_mask:0xf bank_mask:0xf
  v_perm_b32 v20, v252, v248, s41
  v_perm_b32 v21, v252, v248, s42
  v_perm_b32 v22, v253, v249, s41
  v_perm_b32 v23, v253, v249, s42
  s_waitcnt vmcnt(4)
  buffer_load_dwordx4 v[192:195], v44, s[32:35], s40 offen nt
  s_add_u32 s40, s40, 8192
  v_perm_b32 v24, v254, v250, s41
  v_perm_b32 v25, v254, v250, s42
  v_perm_b32 v26, v255, v251, s41
  v_perm_b32 v27, v255, v251, s42
  v_dot2c_f32_bf16_dpp v8, v48, v20 row_newbcast:13 row_mask:0xf bank_mask:0xf
  v_dot2c_f32_bf16_dpp v9, v48, v21 row_newbcast:13 row_mask:0xf bank_mask:0xf
  v_dot2c_f32_bf16_dpp v10, v48, v22 row_newbcast:13 row_mask:0xf bank_mask:0xf
  v_dot2c_f32_bf16_dpp v11, v48, v23 row_newbcast:13 row_mask:0xf bank_mask:0xf
  s_waitcnt vmcnt(4)
  buffer_load_dwordx4 v[196:199], v44, s[32:35], s40 offen nt
  s_add_u32 s40, s40, 8192
  v_dot2c_f32_bf16_dpp v12, v48, v24 row_newbcast:13 row_mask:0xf bank_mask:0xf
  v_dot2c_f32_bf16_dpp v13, v48, v25 row_newbcast:13 row_mask:0xf bank_mask:0xf
  v_dot2c_f32_bf16_dpp v14, v48, v26 row_newbcast:13 row_mask:0xf bank_mask:0xf
  v_dot2c_f32_bf16_dpp v15, v48, v27 row_newbcast:13 row_mask:0xf bank_mask:0xf
  v_perm_b32 v20, v132, v128, s41
  v_perm_b32 v21, v132, v128, s42
  v_perm_b32 v22, v133, v129, s41
  v_perm_b32 v23, v133, v129, s42
  v_add_u32 v58, 1, v58
  ds_write_b32 v59, v58 offset:27008
  s_waitcnt vmcnt(4)
  buffer_load_dwordx4 v[200:203], v44, s[32:35], s40 offen nt
  s_add_u32 s40, s40, 8192
  v_perm_b32 v24, v134, v130, s41
  v_perm_b32 v25, v134, v130, s42
  v_perm_b32 v26, v135, v131, s41
  v_perm_b32 v27, v135, v131, s42
  v_dot2c_f32_bf16_dpp v8, v48, v20 row_newbcast:2 row_mask:0xf bank_mask:0xf
  v_dot2c_f32_bf16_dpp v9, v48, v21 row_newbcast:2 row_mask:0xf bank_mask:0xf
  v_dot2c_f32_bf16_dpp v10, v48, v22 row_newbcast:2 row_mask:0xf bank_mask:0xf
  v_dot2c_f32_bf16_dpp v11, v48, v23 row_newbcast:2 row_mask:0xf bank_mask:0xf
  s_waitcnt vmcnt(4)
  buffer_load_dwordx4 v[204:207], v44, s[32:35], s40 offen nt
  s_add_u32 s40, s40, 8192
  v_dot2c_f32_bf16_dpp v12, v48, v24 row_newbcast:2 row_mask:0xf bank_mask:0xf
  v_dot2c_f32_bf16_dpp v13, v48, v25 row_newbcast:2 row_mask:0xf bank_mask:0xf
  v_dot2c_f32_bf16_dpp v14, v48, v26 row_newbcast:2 row_mask:0xf bank_mask:0xf
  v_dot2c_f32_bf16_dpp v15, v48, v27 row_newbcast:2 row_mask:0xf bank_mask:0xf
  v_perm_b32 v20, v140, v136, s41
  v_perm_b32 v21, v140, v136, s42
  v_perm_b32 v22, v141, v137, s41
  v_perm_b32 v23, v141, v137, s42
  s_waitcnt vmcnt(4)
  buffer_load_dwordx4 v[208:211], v44, s[32:35], s40 offen nt
  s_add_u32 s40, s40, 8192
  v_perm_b32 v24, v142, v138, s41
  v_perm_b32 v25, v142, v138, s42
  v_perm_b32 v26, v143, v139, s41
  v_perm_b32 v27, v143, v139, s42
  v_dot2c_f32_bf16_dpp v8, v48, v20 row_newbcast:10 row_mask:0xf bank_mask:0xf
  v_dot2c_f32_bf16_dpp v9, v48, v21 row_newbcast:10 row_mask:0xf bank_mask:0xf
  v_dot2c_f32_bf16_dpp v10, v48, v22 row_newbcast:10 row_mask:0xf bank_mask:0xf
  v_dot2c_f32_bf16_dpp v11, v48, v23 row_newbcast:10 row_mask:0xf bank_mask:0xf
  v_dot2c_f32_bf16_dpp v12, v48, v24 row_newbcast:10 row_mask:0xf bank_mask:0xf
  s_waitcnt vmcnt(4)
  buffer_load_dwordx4 v[212:215], v44, s[32:35], s40 offen nt
  s_add_u32 s40, s40, 8192
  v_dot2c_f32_bf16_dpp v13, v48, v25 row_newbcast:10 row_mask:0xf bank_mask:0xf
  v_dot2c_f32_bf16_dpp v14, v48, v26 row_newbcast:10 row_mask:0xf bank_mask:0xf
  v_dot2c_f32_bf16_dpp v15, v48, v27 row_newbcast:10 row_mask:0xf bank_mask:0xf
  v_perm_b32 v20, v148, v144, s41
  v_perm_b32 v21, v148, v144, s42
  v_perm_b32 v22, v149, v145, s41
  v_perm_b32 v23, v149, v145, s42
  v_perm_b32 v24, v150, v146, s41
  s_waitcnt vmcnt(4)
  buffer_load_dwordx4 v[216:219], v44, s[32:35], s40 offen nt
  s_add_u32 s40, s40, 8192
  v_perm_b32 v25, v150, v146, s42
  v_perm_b32 v26, v151, v147, s41
  v_perm_b32 v27, v151, v147, s42
  v_dot2c_f32_bf16_dpp v8, v48, v20 row_newbcast:6 row_mask:0xf bank_mask:0xf
  v_dot2c_f32_bf16_dpp v9, v48, v21 row_newbcast:6 row_mask:0xf bank_mask:0xf
  v_dot2c_f32_bf16_dpp v10, v48, v22 row_newbcast:6 row_mask:0xf bank_mask:0xf
  v_dot2c_f32_bf16_dpp v11, v48, v23 row_newbcast:6 row_mask:0xf bank_mask:0xf
  v_dot2c_f32_bf16_dpp v12, v48, v24 row_newbcast:6 row_mask:0xf bank_mask:0xf
  s_waitcnt vmcnt(4)
  buffer_load_dwordx4 v[220:223], v44, s[32:35], s40 offen nt
  s_add_u32 s40, s40, 8192
  v_dot2c_f32_bf16_dpp v13, v48, v25 row_newbcast:6 row_mask:0xf bank_mask:0xf
  v_dot2c_f32_bf16_dpp v14, v48, v26 row_newbcast:6 row_mask:0xf bank_mask:0xf
  v_dot2c_f32_bf16_dpp v15, v48, v27 row_newbcast:6 row_mask:0xf bank_mask:0xf
  v_perm_b32 v20, v156, v152, s41
  v_perm_b32 v21, v156, v152, s42
  v_perm_b32 v22, v157, v153, s41
  v_perm_b32 v23, v157, v153, s42
  v_perm_b32 v24, v158, v154, s41
  s_waitcnt vmcnt(4)
  buffer_load_dwordx4 v[224:227], v44, s[32:35], s40 offen nt
  s_add_u32 s40, s40, 8192
  v_perm_b32 v25, v158, v154, s42
  v_perm_b32 v26, v159, v155, s41
  v_perm_b32 v27, v159, v155, s42
  v_dot2c_f32_bf16_dpp v8, v48, v20 row_newbcast:14 row_mask:0xf bank_mask:0xf
  v_dot2c_f32_bf16_dpp v9, v48, v21 row_newbcast:14 row_mask:0xf bank_mask:0xf
  v_dot2c_f32_bf16_dpp v10, v48, v22 row_newbcast:14 row_mask:0xf bank_mask:0xf
  v_dot2c_f32_bf16_dpp v11, v48, v23 row_newbcast:14 row_mask:0xf bank_mask:0xf
  v_dot2c_f32_bf16_dpp v12, v48, v24 row_newbcast:14 row_mask:0xf bank_mask:0xf
  v_dot2c_f32_bf16_dpp v13, v48, v25 row_newbcast:14 row_mask:0xf bank_mask:0xf
  s_waitcnt vmcnt(4)
  buffer_load_dwordx4 v[228:231], v44, s[32:35], s40 offen nt
  s_add_u32 s40, s40, 8192
  v_dot2c_f32_bf16_dpp v14, v48, v26 row_newbcast:14 row_mask:0xf bank_mask:0xf
  v_dot2c_f32_bf16_dpp v15, v48, v27 row_newbcast:14 row_mask:0xf bank_mask:0xf
  v_perm_b32 v20, v164, v160, s41
  v_perm_b32 v21, v164, v160, s42
  v_perm_b32 v22, v165, v161, s41
  v_perm_b32 v23, v165, v161, s42
  v_perm_b32 v24, v166, v162, s41
  v_perm_b32 v25, v166, v162, s42
  s_waitcnt vmcnt(4)
  buffer_load_dwordx4 v[232:235], v44, s[32:35], s40 offen nt
  s_add_u32 s40, s40, 8192
  v_perm_b32 v26, v167, v163, s41
  v_perm_b32 v27, v167, v163, s42
  v_dot2c_f32_bf16_dpp v8, v48, v20 row_newbcast:3 row_mask:0xf bank_mask:0xf
  v_dot2c_f32_bf16_dpp v9, v48, v21 row_newbcast:3 row_mask:0xf bank_mask:0xf
  v_dot2c_f32_bf16_dpp v10, v48, v22 row_newbcast:3 row_mask:0xf bank_mask:0xf
  v_dot2c_f32_bf16_dpp v11, v48, v23 row_newbcast:3 row_mask:0xf bank_mask:0xf
  v_dot2c_f32_bf16_dpp v12, v48, v24 row_newbcast:3 row_mask:0xf bank_mask:0xf
  v_dot2c_f32_bf16_dpp v13, v48, v25 row_newbcast:3 row_mask:0xf bank_mask:0xf
  s_waitcnt vmcnt(4)
  buffer_load_dwordx4 v[236:239], v44, s[32:35], s40 offen nt
  s_add_u32 s40, s40, 8192
  v_dot2c_f32_bf16_dpp v14, v48, v26 row_newbcast:3 row_mask:0xf bank_mask:0xf
  v_dot2c_f32_bf16_dpp v15, v48, v27 row_newbcast:3 row_mask:0xf bank_mask:0xf
  v_perm_b32 v20, v172, v168, s41
  v_perm_b32 v21, v172, v168, s42
  v_perm_b32 v22, v173, v169, s41
  v_perm_b32 v23, v173, v169, s42
  v_perm_b32 v24, v174, v170, s41
  v_perm_b32 v25, v174, v170, s42
  s_waitcnt vmcnt(4)
  buffer_load_dwordx4 v[240:243], v44, s[32:35], s40 offen nt
  s_add_u32 s40, s40, 8192
  v_perm_b32 v26, v175, v171, s41
  v_perm_b32 v27, v175, v171, s42
  v_dot2c_f32_bf16_dpp v8, v48, v20 row_newbcast:11 row_mask:0xf bank_mask:0xf
  v_dot2c_f32_bf16_dpp v9, v48, v21 row_newbcast:11 row_mask:0xf bank_mask:0xf
  v_dot2c_f32_bf16_dpp v10, v48, v22 row_newbcast:11 row_mask:0xf bank_mask:0xf
  v_dot2c_f32_bf16_dpp v11, v48, v23 row_newbcast:11 row_mask:0xf bank_mask:0xf
  v_dot2c_f32_bf16_dpp v12, v48, v24 row_newbcast:11 row_mask:0xf bank_mask:0xf
  v_dot2c_f32_bf16_dpp v13, v48, v25 row_newbcast:11 row_mask:0xf bank_mask:0xf
  s_waitcnt vmcnt(4)
  buffer_load_dwordx4 v[244:247], v44, s[32:35], s40 offen nt
  s_add_u32 s40, s40, 8192
  v_dot2c_f32_bf16_dpp v14, v48, v26 row_newbcast:11 row_mask:0xf bank_mask:0xf
  v_dot2c_f32_bf16_dpp v15, v48, v27 row_newbcast:11 row_mask:0xf bank_mask:0xf
  v_perm_b32 v20, v180, v176, s41
  v_perm_b32 v21, v180, v176, s42
  v_perm_b32 v22, v181, v177, s41
  v_perm_b32 v23, v181, v177, s42
  v_perm_b32 v24, v182, v178, s41
  v_perm_b32 v25, v182, v178, s42
  v_perm_b32 v26, v183, v179, s41
  s_waitcnt vmcnt(4)
  buffer_load_dwordx4 v[248:251], v44, s[32:35], s40 offen nt
  s_add_u32 s40, s40, 8192
  v_perm_b32 v27, v183, v179, s42
  v_dot2c_f32_bf16_dpp v8, v48, v20 row_newbcast:7 row_mask:0xf bank_mask:0xf
  v_dot2c_f32_bf16_dpp v9, v48, v21 row_newbcast:7 row_mask:0xf bank_mask:0xf
  v_dot2c_f32_bf16_dpp v10, v48, v22 row_newbcast:7 row_mask:0xf bank_mask:0xf
  v_dot2c_f32_bf16_dpp v11, v48, v23 row_newbcast:7 row_mask:0xf bank_mask:0xf
  v_dot2c_f32_bf16_dpp v12, v48, v24 row_newbcast:7 row_mask:0xf bank_mask:0xf
  v_dot2c_f32_bf16_dpp v13, v48, v25 row_newbcast:7 row_mask:0xf bank_mask:0xf
  v_dot2c_f32_bf16_dpp v14, v48, v26 row_newbcast:7 row_mask:0xf bank_mask:0xf
  ds_read_b32 v61, v62 offset:27024
  s_waitcnt vmcnt(4)
  buffer_load_dwordx4 v[252:255], v44, s[32:35], s40 offen nt
  s_add_u32 s40, s40, 8192
  v_dot2c_f32_bf16_dpp v15, v48, v27 row_newbcast:7 row_mask:0xf bank_mask:0xf
  v_perm_b32 v20, v188, v184, s41
  v_perm_b32 v21, v188, v184, s42
  v_perm_b32 v22, v189, v185, s41
  v_perm_b32 v23, v189, v185, s42
  v_perm_b32 v24, v190, v186, s41
  v_perm_b32 v25, v190, v186, s42
  v_perm_b32 v26, v191, v187, s41
  s_waitcnt vmcnt(4)
  buffer_load_dwordx4 v[128:131], v44, s[32:35], s40 offen nt
  s_add_u32 s40, s40, 8192
  v_perm_b32 v27, v191, v187, s42
  v_dot2c_f32_bf16_dpp v8, v48, v20 row_newbcast:15 row_mask:0xf bank_mask:0xf
  v_dot2c_f32_bf16_dpp v9, v48, v21 row_newbcast:15 row_mask:0xf bank_mask:0xf
  v_dot2c_f32_bf16_dpp v10, v48, v22 row_newbcast:15 row_mask:0xf bank_mask:0xf
  v_dot2c_f32_bf16_dpp v11, v48, v23 row_newbcast:15 row_mask:0xf bank_mask:0xf
  v_dot2c_f32_bf16_dpp v12, v48, v24 row_newbcast:15 row_mask:0xf bank_mask:0xf
  v_dot2c_f32_bf16_dpp v13, v48, v25 row_newbcast:15 row_mask:0xf bank_mask:0xf
  v_dot2c_f32_bf16_dpp v14, v48, v26 row_newbcast:15 row_mask:0xf bank_mask:0xf
  s_waitcnt vmcnt(4)
  buffer_load_dwordx4 v[132:135], v44, s[32:35], s40 offen nt
  s_add_u32 s40, s40, 8192
  v_dot2c_f32_bf16_dpp v15, v48, v27 row_newbcast:15 row_mask:0xf bank_mask:0xf
  v_mov_b32 v48, v49
  v_mov_b32 v49, v50
  v_mov_b32 v50, v51
  v_mov_b32 v51, v52
  v_mov_b32 v52, v53
  v_mov_b32 v53, v54
  v_mov_b32 v54, v55
  s_sub_u32 s55, s55, 1
  s_cmp_lg_u32 s55, 0
  s_cbranch_scc1 L_vloop
  s_branch L_vloop_x
L_vloop_f:
  s_waitcnt vmcnt(5)
  buffer_load_dwordx4 v[136:139], v44, s[32:35], s40 offen nt
  s_add_u32 s40, s40, 8192
  v_perm_b32 v20, v196, v192, s41
  v_perm_b32 v21, v196, v192, s42
  v_perm_b32 v22, v197, v193, s41
  v_perm_b32 v23, v197, v193, s42
  v_perm_b32 v24, v198, v194, s41
  v_perm_b32 v25, v198, v194, s42
  v_perm_b32 v26, v199, v195, s41
  v_perm_b32 v27, v199, v195, s42
  v_dot2c_f32_bf16_dpp v8, v48, v20 row_newbcast:0 row_mask:0xf bank_mask:0xf
  s_waitcnt vmcnt(5)
  buffer_load_dwordx4 v[140:143], v44, s[32:35], s40 offen nt
  s_add_u32 s40, s40, 8192
  v_dot2c_f32_bf16_dpp v9, v48, v21 row_newbcast:0 row_mask:0xf bank_mask:0xf
  v_dot2c_f32_bf16_dpp v10, v48, v22 row_newbcast:0 row_mask:0xf bank_mask:0xf
  v_dot2c_f32_bf16_dpp v11, v48, v23 row_newbcast:0 row_mask:0xf bank_mask:0xf
  v_dot2c_f32_bf16_dpp v12, v48, v24 row_newbcast:0 row_mask:0xf bank_mask:0xf
  v_dot2c_f32_bf16_dpp v13, v48, v25 row_newbcast:0 row_mask:0xf bank_mask:0xf
  v_dot2c_f32_bf16_dpp v14, v48, v26 row_newbcast:0 row_mask:0xf bank_mask:0xf
  v_dot2c_f32_bf16_dpp v15, v48, v27 row_newbcast:0 row_mask:0xf bank_mask:0xf
  v_perm_b32 v20, v204, v200, s41
  s_waitcnt vmcnt(5)
  buffer_load_dwordx4 v[144:147], v44, s[32:35], s40 offen nt
  s_add_u32 s40, s40, 8192
  v_perm_b32 v21, v204, v200, s42
  v_perm_b32 v22, v205, v201, s41
  v_perm_b32 v23, v205, v201, s42
  v_perm_b32 v24, v206, v202, s41
  v_perm_b32 v25, v206, v202, s42
  v_perm_b32 v26, v207, v203, s41
  v_perm_b32 v27, v207, v203, s42
  v_dot2c_f32_bf16_dpp v8, v48, v20 row_newbcast:8 row_mask:0xf bank_mask:0xf
  s_waitcnt vmcnt(5)
  buffer_load_dwordx4 v[148:151], v44, s[32:35], s40 offen nt
  s_add_u32 s40, s40, 8192
  v_dot2c_f32_bf16_dpp v9, v48, v21 row_newbcast:8 row_mask:0xf bank_mask:0xf
  v_dot2c_f32_bf16_dpp v10, v48, v22 row_newbcast:8 row_mask:0xf bank_mask:0xf
  v_dot2c_f32_bf16_dpp v11, v48, v23 row_newbcast:8 row_mask:0xf bank_mask:0xf
  v_dot2c_f32_bf16_dpp v12, v48, v24 row_newbcast:8 row_mask:0xf bank_mask:0xf
  v_dot2c_f32_bf16_dpp v13, v48, v25 row_newbcast:8 row_mask:0xf bank_mask:0xf
  v_dot2c_f32_bf16_dpp v14, v48, v26 row_newbcast:8 row_mask:0xf bank_mask:0xf
  v_dot2c_f32_bf16_dpp v15, v48, v27 row_newbcast:8 row_mask:0xf bank_mask:0xf
  v_perm_b32 v20, v212, v208, s41
  s_waitcnt vmcnt(5)
  buffer_load_dwordx4 v[152:155], v44, s[32:35], s40 offen nt
  s_add_u32 s40, s40, 8192
  v_perm_b32 v21, v212, v208, s42
  v_perm_b32 v22, v213, v209, s41
  v_perm_b32 v23, v213, v209, s42
  v_perm_b32 v24, v214, v210, s41
  v_perm_b32 v25, v214, v210, s42
  v_perm_b32 v26, v215, v211, s41
  v_perm_b32 v27, v215, v211, s42
  v_dot2c_f32_bf16_dpp v8, v48, v20 row_newbcast:4 row_mask:0xf bank_mask:0xf
  v_dot2c_f32_bf16_dpp v9, v48, v21 row_newbcast:4 row_mask:0xf bank_mask:0xf
  s_waitcnt vmcnt(5)
  buffer_load_dwordx4 v[156:159], v44, s[32:35], s40 offen nt
  s_add_u32 s40, s40, 8192
  v_dot2c_f32_bf16_dpp v10, v48, v22 row_newbcast:4 row_mask:0xf bank_mask:0xf
  v_dot2c_f32_bf16_dpp v11, v48, v23 row_newbcast:4 row_mask:0xf bank_mask:0xf
  v_dot2c_f32_bf16_dpp v12, v48, v24 row_newbcast:4 row_mask:0xf bank_mask:0xf
  v_dot2c_f32_bf16_dpp v13, v48, v25 row_newbcast:4 row_mask:0xf bank_mask:0xf
  v_dot2c_f32_bf16_dpp v14, v48, v26 row_newbcast:4 row_mask:0xf bank_mask:0xf
  v_dot2c_f32_bf16_dpp v15, v48, v27 row_newbcast:4 row_mask:0xf bank_mask:0xf
  v_perm_b32 v20, v220, v216, s41
  v_perm_b32 v21, v220, v216, s42
  s_waitcnt vmcnt(5)
  buffer_load_dwordx4 v[160:163], v44, s[32:35], s40 offen nt
  s_add_u32 s40, s40, 8192
  v_perm_b32 v22, v221, v217, s41
  v_perm_b32 v23, v221, v217, s42
  v_perm_b32 v24, v222, v218, s41
  v_perm_b32 v25, v222, v218, s42
  v_perm_b32 v26, v223, v219, s41
  v_perm_b32 v27, v223, v219, s42
  v_dot2c_f32_bf16_dpp v8, v48, v20 row_newbcast:12 row_mask:0xf bank_mask:0xf
  v_dot2c_f32_bf16_dpp v9, v48, v21 row_newbcast:12 row_mask:0xf bank_mask:0xf
  s_waitcnt vmcnt(5)
  buffer_load_dwordx4 v[164:167], v44, s[32:35], s40 offen nt
  s_add_u32 s40, s40, 8192
  v_dot2c_f32_bf16_dpp v10, v48, v22 row_newbcast:12 row_mask:0xf bank_mask:0xf
  v_dot2c_f32_bf16_dpp v11, v48, v23 row_newbcast:12 row_mask:0xf bank_mask:0xf
  v_dot2c_f32_bf16_dpp v12, v48, v24 row_newbcast:12 row_mask:0xf bank_mask:0xf
  v_dot2c_f32_bf16_dpp v13, v48, v25 row_newbcast:12 row_mask:0xf bank_mask:0xf
  v_dot2c_f32_bf16_dpp v14, v48, v26 row_newbcast:12 row_mask:0xf bank_mask:0xf
  v_dot2c_f32_bf16_dpp v15, v48, v27 row_newbcast:12 row_mask:0xf bank_mask:0xf
  v_perm_b32 v20, v228, v224, s41
  v_perm_b32 v21, v228, v224, s42
  s_waitcnt vmcnt(5)
  buffer_load_dwordx4 v[168:171], v44, s[32:35], s40 offen nt
  s_add_u32 s40, s40, 8192
  v_perm_b32 v22, v229, v225, s41
  v_perm_b32 v23, v229, v225, s42
  v_perm_b32 v24, v230, v226, s41
  v_perm_b32 v25, v230, v226, s42
  v_perm_b32 v26, v231, v227, s41
  v_perm_b32 v27, v231, v227, s42
  v_dot2c_f32_bf16_dpp v8, v48, v20 row_newbcast:1 row_mask:0xf bank_mask:0xf
  v_dot2c_f32_bf16_dpp v9, v48, v21 row_newbcast:1 row_mask:0xf bank_mask:0xf
  s_waitcnt vmcnt(5)
  buffer_load_dwordx4 v[172:175], v44, s[32:35], s40 offen nt
  s_add_u32 s40, s40, 8192
  v_dot2c_f32_bf16_dpp v10, v48, v22 row_newbcast:1 row_mask:0xf bank_mask:0xf
  v_dot2c_f32_bf16_dpp v11, v48, v23 row_newbcast:1 row_mask:0xf bank_mask:0xf
  v_dot2c_f32_bf16_dpp v12, v48, v24 row_newbcast:1 row_mask:0xf bank_mask:0xf
  v_dot2c_f32_bf16_dpp v13, v48, v25 row_newbcast:1 row_mask:0xf bank_mask:0xf
  v_dot2c_f32_bf16_dpp v14, v48, v26 row_newbcast:1 row_mask:0xf bank_mask:0xf
  v_dot2c_f32_bf16_dpp v15, v48, v27 row_newbcast:1 row_mask:0xf bank_mask:0xf
  v_perm_b32 v20, v236, v232, s41
  v_perm_b32 v21, v236, v232, s42
  v_perm_b32 v22, v237, v233, s41
  s_waitcnt vmcnt(5)
  buffer_load_dwordx4 v[176:179], v44, s[32:35], s40 offen nt
  s_add_u32 s40, s40, 8192
  v_perm_b32 v23, v237, v233, s42
  v_perm_b32 v24, v238, v234, s41
  v_perm_b32 v25, v238, v234, s42
  v_perm_b32 v26, v239, v235, s41
  v_perm_b32 v27, v239, v235, s42
  v_dot2c_f32_bf16_dpp v8, v48, v20 row_newbcast:9 row_mask:0xf bank_mask:0xf
  v_dot2c_f32_bf16_dpp v9, v48, v21 row_newbcast:9 row_mask:0xf bank_mask:0xf
  v_dot2c_f32_bf16_dpp v10, v48, v22 row_newbcast:9 row_mask:0xf bank_mask:0xf
  s_waitcnt vmcnt(5)
  buffer_load_dwordx4 v[180:183], v44, s[32:35], s40 offen nt
  s_add_u32 s40, s40, 8192
  v_dot2c_f32_bf16_dpp v11, v48, v23 row_newbcast:9 row_mask:0xf bank_mask:0xf
  v_dot2c_f32_bf16_dpp v12, v48, v24 row_newbcast:9 row_mask:0xf bank_mask:0xf
  v_dot2c_f32_bf16_dpp v13, v48, v25 row_newbcast:9 row_mask:0xf bank_mask:0xf
  v_dot2c_f32_bf16_dpp v14, v48, v26 row_newbcast:9 row_mask:0xf bank_mask:0xf
  v_dot2c_f32_bf16_dpp v15, v48, v27 row_newbcast:9 row_mask:0xf bank_mask:0xf
  v_perm_b32 v20, v244, v240, s41
  v_perm_b32 v21, v244, v240, s42
  v_perm_b32 v22, v245, v241, s41
  s_waitcnt vmcnt(5)
  buffer_load_dwordx4 v[184:187], v44, s[32:35], s40 offen nt
  s_add_u32 s40, s40, 8192
  v_perm_b32 v23, v245, v241, s42
  v_perm_b32 v24, v246, v242, s41
  v_perm_b32 v25, v246, v242, s42
  v_perm_b32 v26, v247, v243, s41
  v_perm_b32 v27, v247, v243, s42
  v_dot2c_f32_bf16_dpp v8, v48, v20 row_newbcast:5 row_mask:0xf bank_mask:0xf
  v_dot2c_f32_bf16_dpp v9, v48, v21 row_newbcast:5 row_mask:0xf bank_mask:0xf
  v_dot2c_f32_bf16_dpp v10, v48, v22 row_newbcast:5 row_mask:0xf bank_mask:0xf
  s_waitcnt vmcnt(5)
  buffer_load_dwordx4 v[188:191], v44, s[32:35], s40 offen nt
  s_add_u32 s40, s40, 8192
  v_dot2c_f32_bf16_dpp v11, v48, v23 row_newbcast:5 row_mask:0xf bank_mask:0xf
  v_dot2c_f32_bf16_dpp v12, v48, v24 row_newbcast:5 row_mask:0xf bank_mask:0xf
  v_dot2c_f32_bf16_dpp v13, v48, v25 row_newbcast:5 row_mask:0xf bank_mask:0xf
  v_dot2c_f32_bf16_dpp v14, v48, v26 row_newbcast:5 row_mask:0xf bank_mask:0xf
  v_dot2c_f32_bf16_dpp v15, v48, v27 row_newbcast:5 row_mask:0xf bank_mask:0xf
  v_perm_b32 v20, v252, v248, s41
  v_perm_b32 v21, v252, v248, s42
  v_perm_b32 v22, v253, v249, s41
  v_perm_b32 v23, v253, v249, s42
  s_waitcnt vmcnt(5)
  buffer_load_dwordx4 v[192:195], v44, s[32:35], s40 offen nt
  s_add_u32 s40, s40, 8192
  v_perm_b32 v24, v254, v250, s41
  v_perm_b32 v25, v254, v250, s42
  v_perm_b32 v26, v255, v251, s41
  v_perm_b32 v27, v255, v251, s42
  v_dot2c_f32_bf16_dpp v8, v48, v20 row_newbcast:13 row_mask:0xf bank_mask:0xf
  v_dot2c_f32_bf16_dpp v9, v48, v21 row_newbcast:13 row_mask:0xf bank_mask:0xf
  v_dot2c_f32_bf16_dpp v10, v48, v22 row_newbcast:13 row_mask:0xf bank_mask:0xf
  v_dot2c_f32_bf16_dpp v11, v48, v23 row_newbcast:13 row_mask:0xf bank_mask:0xf
  s_waitcnt vmcnt(5)
  buffer_load_dwordx4 v[196:199], v44, s[32:35], s40 offen nt
  s_add_u32 s40, s40, 8192
  v_dot2c_f32_bf16_dpp v12, v48, v24 row_newbcast:13 row_mask:0xf bank_mask:0xf
  v_dot2c_f32_bf16_dpp v13, v48, v25 row_newbcast:13 row_mask:0xf bank_mask:0xf
  v_dot2c_f32_bf16_dpp v14, v48, v26 row_newbcast:13 row_mask:0xf bank_mask:0xf
  v_dot2c_f32_bf16_dpp v15, v48, v27 row_newbcast:13 row_mask:0xf bank_mask:0xf
  v_perm_b32 v20, v132, v128, s41
  v_perm_b32 v21, v132, v128, s42
  v_perm_b32 v22, v133, v129, s41
  v_perm_b32 v23, v133, v129, s42
  v_add_u32 v58, 1, v58
  ds_write_b32 v59, v58 offset:27008
  s_waitcnt vmcnt(5)
  buffer_load_dwordx4 v[200:203], v44, s[32:35], s40 offen nt
  s_add_u32 s40, s40, 8192
  v_perm_b32 v24, v134, v130, s41
  v_perm_b32 v25, v134, v130, s42
  v_perm_b32 v26, v135, v131, s41
  v_perm_b32 v27, v135, v131, s42
  v_dot2c_f32_bf16_dpp v8, v48, v20 row_newbcast:2 row_mask:0xf bank_mask:0xf
  v_dot2c_f32_bf16_dpp v9, v48, v21 row_newbcast:2 row_mask:0xf bank_mask:0xf
  v_dot2c_f32_bf16_dpp v10, v48, v22 row_newbcast:2 row_mask:0xf bank_mask:0xf
  v_dot2c_f32_bf16_dpp v11, v48, v23 row_newbcast:2 row_mask:0xf bank_mask:0xf
  s_waitcnt vmcnt(5)
  buffer_load_dwordx4 v[204:207], v44, s[32:35], s40 offen nt
  s_add_u32 s40, s40, 8192
  v_dot2c_f32_bf16_dpp v12, v48, v24 row_newbcast:2 row_mask:0xf bank_mask:0xf
  v_dot2c_f32_bf16_dpp v13, v48, v25 row_newbcast:2 row_mask:0xf bank_mask:0xf
  v_dot2c_f32_bf16_dpp v14, v48, v26 row_newbcast:2 row_mask:0xf bank_mask:0xf
  v_dot2c_f32_bf16_dpp v15, v48, v27 row_newbcast:2 row_mask:0xf bank_mask:0xf
  v_perm_b32 v20, v140, v136, s41
  v_perm_b32 v21, v140, v136, s42
  v_perm_b32 v22, v141, v137, s41
  v_perm_b32 v23, v141, v137, s42
  s_waitcnt vmcnt(5)
  buffer_load_dwordx4 v[208:211], v44, s[32:35], s40 offen nt
  s_add_u32 s40, s40, 8192
  v_perm_b32 v24, v142, v138, s41
  v_perm_b32 v25, v142, v138, s42
  v_perm_b32 v26, v143, v139, s41
  v_perm_b32 v27, v143, v139, s42
  v_dot2c_f32_bf16_dpp v8, v48, v20 row_newbcast:10 row_mask:0xf bank_mask:0xf
  v_dot2c_f32_bf16_dpp v9, v48, v21 row_newbcast:10 row_mask:0xf bank_mask:0xf
  v_dot2c_f32_bf16_dpp v10, v48, v22 row_newbcast:10 row_mask:0xf bank_mask:0xf
  v_dot2c_f32_bf16_dpp v11, v48, v23 row_newbcast:10 row_mask:0xf bank_mask:0xf
  v_dot2c_f32_bf16_dpp v12, v48, v24 row_newbcast:10 row_mask:0xf bank_mask:0xf
  s_waitcnt vmcnt(5)
  buffer_load_dwordx4 v[212:215], v44, s[32:35], s40 offen nt
  s_add_u32 s40, s40, 8192
  v_dot2c_f32_bf16_dpp v13, v48, v25 row_newbcast:10 row_mask:0xf bank_mask:0xf
  v_dot2c_f32_bf16_dpp v14, v48, v26 row_newbcast:10 row_mask:0xf bank_mask:0xf
  v_dot2c_f32_bf16_dpp v15, v48, v27 row_newbcast:10 row_mask:0xf bank_mask:0xf
  v_perm_b32 v20, v148, v144, s41
  v_perm_b32 v21, v148, v144, s42
  v_perm_b32 v22, v149, v145, s41
  v_perm_b32 v23, v149, v145, s42
  v_perm_b32 v24, v150, v146, s41
  s_waitcnt vmcnt(5)
  buffer_load_dwordx4 v[216:219], v44, s[32:35], s40 offen nt
  s_add_u32 s40, s40, 8192
  v_perm_b32 v25, v150, v146, s42
  v_perm_b32 v26, v151, v147, s41
  v_perm_b32 v27, v151, v147, s42
  v_dot2c_f32_bf16_dpp v8, v48, v20 row_newbcast:6 row_mask:0xf bank_mask:0xf
  v_dot2c_f32_bf16_dpp v9, v48, v21 row_newbcast:6 row_mask:0xf bank_mask:0xf
  v_dot2c_f32_bf16_dpp v10, v48, v22 row_newbcast:6 row_mask:0xf bank_mask:0xf
  v_dot2c_f32_bf16_dpp v11, v48, v23 row_newbcast:6 row_mask:0xf bank_mask:0xf
  v_dot2c_f32_bf16_dpp v12, v48, v24 row_newbcast:6 row_mask:0xf bank_mask:0xf
  s_waitcnt vmcnt(5)
  buffer_load_dwordx4 v[220:223], v44, s[32:35], s40 offen nt
  s_add_u32 s40, s40, 8192
  v_dot2c_f32_bf16_dpp v13, v48, v25 row_newbcast:6 row_mask:0xf bank_mask:0xf
  v_dot2c_f32_bf16_dpp v14, v48, v26 row_newbcast:6 row_mask:0xf bank_mask:0xf
  v_dot2c_f32_bf16_dpp v15, v48, v27 row_newbcast:6 row_mask:0xf bank_mask:0xf
  v_perm_b32 v20, v156, v152, s41
  v_perm_b32 v21, v156, v152, s42
  v_perm_b32 v22, v157, v153, s41
  v_perm_b32 v23, v157, v153, s42
  v_perm_b32 v24, v158, v154, s41
  s_waitcnt vmcnt(5)
  buffer_load_dwordx4 v[224:227], v44, s[32:35], s40 offen nt
  s_add_u32 s40, s40, 8192
  v_perm_b32 v25, v158, v154, s42
  v_perm_b32 v26, v159, v155, s41
  v_perm_b32 v27, v159, v155, s42
  v_dot2c_f32_bf16_dpp v8, v48, v20 row_newbcast:14 row_mask:0xf bank_mask:0xf
  v_dot2c_f32_bf16_dpp v9, v48, v21 row_newbcast:14 row_mask:0xf bank_mask:0xf
  v_dot2c_f32_bf16_dpp v10, v48, v22 row_newbcast:14 row_mask:0xf bank_mask:0xf
  v_dot2c_f32_bf16_dpp v11, v48, v23 row_newbcast:14 row_mask:0xf bank_mask:0xf
  v_dot2c_f32_bf16_dpp v12, v48, v24 row_newbcast:14 row_mask:0xf bank_mask:0xf
  v_dot2c_f32_bf16_dpp v13, v48, v25 row_newbcast:14 row_mask:0xf bank_mask:0xf
  s_waitcnt vmcnt(5)
  buffer_load_dwordx4 v[228:231], v44, s[32:35], s40 offen nt
  s_add_u32 s40, s40, 8192
  v_dot2c_f32_bf16_dpp v14, v48, v26 row_newbcast:14 row_mask:0xf bank_mask:0xf
  v_dot2c_f32_bf16_dpp v15, v48, v27 row_newbcast:14 row_mask:0xf bank_mask:0xf
  v_perm_b32 v20, v164, v160, s41
  v_perm_b32 v21, v164, v160, s42
  v_perm_b32 v22, v165, v161, s41
  v_perm_b32 v23, v165, v161, s42
  v_perm_b32 v24, v166, v162, s41
  v_perm_b32 v25, v166, v162, s42
  s_waitcnt vmcnt(5)
  buffer_load_dwordx4 v[232:235], v44, s[32:35], s40 offen nt
  s_add_u32 s40, s40, 8192
  v_perm_b32 v26, v167, v163, s41
  v_perm_b32 v27, v167, v163, s42
  v_dot2c_f32_bf16_dpp v8, v48, v20 row_newbcast:3 row_mask:0xf bank_mask:0xf
  v_dot2c_f32_bf16_dpp v9, v48, v21 row_newbcast:3 row_mask:0xf bank_mask:0xf
  v_dot2c_f32_bf16_dpp v10, v48, v22 row_newbcast:3 row_mask:0xf bank_mask:0xf
  v_dot2c_f32_bf16_dpp v11, v48, v23 row_newbcast:3 row_mask:0xf bank_mask:0xf
  v_dot2c_f32_bf16_dpp v12, v48, v24 row_newbcast:3 row_mask:0xf bank_mask:0xf
  v_dot2c_f32_bf16_dpp v13, v48, v25 row_newbcast:3 row_mask:0xf bank_mask:0xf
  s_waitcnt vmcnt(5)
  buffer_load_dwordx4 v[236:239], v44, s[32:35], s40 offen nt
  s_add_u32 s40, s40, 8192
  v_dot2c_f32_bf16_dpp v14, v48, v26 row_newbcast:3 row_mask:0xf bank_mask:0xf
  v_dot2c_f32_bf16_dpp v15, v48, v27 row_newbcast:3 row_mask:0xf bank_mask:0xf
  v_perm_b32 v20, v172, v168, s41
  v_perm_b32 v21, v172, v168, s42
  v_perm_b32 v22, v173, v169, s41
  v_perm_b32 v23, v173, v169, s42
  v_perm_b32 v24, v174, v170, s41
  v_perm_b32 v25, v174, v170, s42
  s_waitcnt vmcnt(5)
  buffer_load_dwordx4 v[240:243], v44, s[32:35], s40 offen nt
  s_add_u32 s40, s40, 8192
  v_perm_b32 v26, v175, v171, s41
  v_perm_b32 v27, v175, v171, s42
  v_dot2c_f32_bf16_dpp v8, v48, v20 row_newbcast:11 row_mask:0xf bank_mask:0xf
  v_dot2c_f32_bf16_dpp v9, v48, v21 row_newbcast:11 row_mask:0xf bank_mask:0xf
  v_dot2c_f32_bf16_dpp v10, v48, v22 row_newbcast:11 row_mask:0xf bank_mask:0xf
  v_dot2c_f32_bf16_dpp v11, v48, v23 row_newbcast:11 row_mask:0xf bank_mask:0xf
  v_dot2c_f32_bf16_dpp v12, v48, v24 row_newbcast:11 row_mask:0xf bank_mask:0xf
  v_dot2c_f32_bf16_dpp v13, v48, v25 row_newbcast:11 row_mask:0xf bank_mask:0xf
  s_waitcnt vmcnt(5)
  buffer_load_dwordx4 v[244:247], v44, s[32:35], s40 offen nt
  s_add_u32 s40, s40, 8192
  v_dot2c_f32_bf16_dpp v14, v48, v26 row_newbcast:11 row_mask:0xf bank_mask:0xf
  v_dot2c_f32_bf16_dpp v15, v48, v27 row_newbcast:11 row_mask:0xf bank_mask:0xf
  v_perm_b32 v20, v180, v176, s41
  v_perm_b32 v21, v180, v176, s42
  v_perm_b32 v22, v181, v177, s41
  v_perm_b32 v23, v181, v177, s42
  v_perm_b32 v24, v182, v178, s41
  v_perm_b32 v25, v182, v178, s42
  v_perm_b32 v26, v183, v179, s41
  s_waitcnt vmcnt(5)
  buffer_load_dwordx4 v[248:251], v44, s[32:35], s40 offen nt
  s_add_u32 s40, s40, 8192
  v_perm_b32 v27, v183, v179, s42
  v_dot2c_f32_bf16_dpp v8, v48, v20 row_newbcast:7 row_mask:0xf bank_mask:0xf
  v_dot2c_f32_bf16_dpp v9, v48, v21 row_newbcast:7 row_mask:0xf bank_mask:0xf
  v_dot2c_f32_bf16_dpp v10, v48, v22 row_newbcast:7 row_mask:0xf bank_mask:0xf
  v_dot2c_f32_bf16_dpp v11, v48, v23 row_newbcast:7 row_mask:0xf bank_mask:0xf
  v_dot2c_f32_bf16_dpp v12, v48, v24 row_newbcast:7 row_mask:0xf bank_mask:0xf
  v_dot2c_f32_bf16_dpp v13, v48, v25 row_newbcast:7 row_mask:0xf bank_mask:0xf
  v_dot2c_f32_bf16_dpp v14, v48, v26 row_newbcast:7 row_mask:0xf bank_mask:0xf
  ds_read_b32 v61, v62 offset:27024
  s_waitcnt vmcnt(5)
  buffer_load_dwordx4 v[252:255], v44, s[32:35], s40 offen nt
  s_add_u32 s40, s40, 8192
  v_dot2c_f32_bf16_dpp v15, v48, v27 row_newbcast:7 row_mask:0xf bank_mask:0xf
  v_perm_b32 v20, v188, v184, s41
  v_perm_b32 v21, v188, v184, s42
  v_perm_b32 v22, v189, v185, s41
  v_perm_b32 v23, v189, v185, s42
  v_perm_b32 v24, v190, v186, s41
  v_perm_b32 v25, v190, v186, s42
  v_perm_b32 v26, v191, v187, s41
  s_waitcnt vmcnt(5)
  buffer_load_dwordx4 v[128:131], v44, s[32:35], s40 offen nt
  s_add_u32 s40, s40, 8192
  v_perm_b32 v27, v191, v187, s42
  v_dot2c_f32_bf16_dpp v8, v48, v20 row_newbcast:15 row_mask:0xf bank_mask:0xf
  v_dot2c_f32_bf16_dpp v9, v48, v21 row_newbcast:15 row_mask:0xf bank_mask:0xf
  v_dot2c_f32_bf16_dpp v10, v48, v22 row_newbcast:15 row_mask:0xf bank_mask:0xf
  v_dot2c_f32_bf16_dpp v11, v48, v23 row_newbcast:15 row_mask:0xf bank_mask:0xf
  v_dot2c_f32_bf16_dpp v12, v48, v24 row_newbcast:15 row_mask:0xf bank_mask:0xf
  v_dot2c_f32_bf16_dpp v13, v48, v25 row_newbcast:15 row_mask:0xf bank_mask:0xf
  v_dot2c_f32_bf16_dpp v14, v48, v26 row_newbcast:15 row_mask:0xf bank_mask:0xf
  s_waitcnt vmcnt(5)
  buffer_load_dwordx4 v[132:135], v44, s[32:35], s40 offen nt
  s_add_u32 s40, s40, 8192
  v_dot2c_f32_bf16_dpp v15, v48, v27 row_newbcast:15 row_mask:0xf bank_mask:0xf
  v_mov_b32 v48, v49
  v_mov_b32 v49, v50
  v_mov_b32 v50, v51
  v_mov_b32 v51, v52
  v_mov_b32 v52, v53
  v_mov_b32 v53, v54
  v_mov_b32 v54, v55
  s_sub_u32 s55, s55, 1
  s_cmp_lg_u32 s55, 0
  s_cbranch_scc1 L_vloop
L_vloop_x:
  s_mov_b32 s55, 1
L_vloopE:
  s_waitcnt vmcnt(7)
  buffer_load_dwordx4 v[136:139], v44, s[32:35], s40 offen nt
  s_add_u32 s40, s40, 8192
  v_perm_b32 v20, v196, v192, s41
  v_perm_b32 v21, v196, v192, s42
  v_perm_b32 v22, v197, v193, s41
  v_perm_b32 v23, v197, v193, s42
  v_perm_b32 v24, v198, v194, s41
  v_perm_b32 v25, v198, v194, s42
  v_perm_b32 v26, v199, v195, s41
  v_perm_b32 v27, v199, v195, s42
  v_dot2c_f32_bf16_dpp v8, v48, v20 row_newbcast:0 row_mask:0xf bank_mask:0xf
  s_waitcnt vmcnt(7)
  buffer_load_dwordx4 v[140:143], v44, s[32:35], s40 offen nt
  s_add_u32 s40, s40, 8192
  v_dot2c_f32_bf16_dpp v9, v48, v21 row_newbcast:0 row_mask:0xf bank_mask:0xf
  v_dot2c_f32_bf16_dpp v10, v48, v22 row_newbcast:0 row_mask:0xf bank_mask:0xf
  v_dot2c_f32_bf16_dpp v11, v48, v23 row_newbcast:0 row_mask:0xf bank_mask:0xf
  v_dot2c_f32_bf16_dpp v12, v48, v24 row_newbcast:0 row_mask:0xf bank_mask:0xf
  v_dot2c_f32_bf16_dpp v13, v48, v25 row_newbcast:0 row_mask:0xf bank_mask:0xf
  v_dot2c_f32_bf16_dpp v14, v48, v26 row_newbcast:0 row_mask:0xf bank_mask:0xf
  v_dot2c_f32_bf16_dpp v15, v48, v27 row_newbcast:0 row_mask:0xf bank_mask:0xf
  v_perm_b32 v20, v204, v200, s41
  s_waitcnt vmcnt(7)
  buffer_load_dwordx4 v[144:147], v44, s[32:35], s40 offen nt
  s_add_u32 s40, s40, 8192
  v_perm_b32 v21, v204, v200, s42
  v_perm_b32 v22, v205, v201, s41
  v_perm_b32 v23, v205, v201, s42
  v_perm_b32 v24, v206, v202, s41
  v_perm_b32 v25, v206, v202, s42
  v_perm_b32 v26, v207, v203, s41
  v_perm_b32 v27, v207, v203, s42
  v_dot2c_f32_bf16_dpp v8, v48, v20 row_newbcast:8 row_mask:0xf bank_mask:0xf
  s_waitcnt vmcnt(7)
  buffer_load_dwordx4 v[148:151], v44, s[32:35], s40 offen nt
  s_add_u32 s40, s40, 8192
  v_dot2c_f32_bf16_dpp v9, v48, v21 row_newbcast:8 row_mask:0xf bank_mask:0xf
  v_dot2c_f32_bf16_dpp v10, v48, v22 row_newbcast:8 row_mask:0xf bank_mask:0xf
  v_dot2c_f32_bf16_dpp v11, v48, v23 row_newbcast:8 row_mask:0xf bank_mask:0xf
  v_dot2c_f32_bf16_dpp v12, v48, v24 row_newbcast:8 row_mask:0xf bank_mask:0xf
  v_dot2c_f32_bf16_dpp v13, v48, v25 row_newbcast:8 row_mask:0xf bank_mask:0xf
  v_dot2c_f32_bf16_dpp v14, v48, v26 row_newbcast:8 row_mask:0xf bank_mask:0xf
  v_dot2c_f32_bf16_dpp v15, v48, v27 row_newbcast:8 row_mask:0xf bank_mask:0xf
  v_perm_b32 v20, v212, v208, s41
  s_waitcnt vmcnt(7)
  buffer_load_dwordx4 v[152:155], v44, s[32:35], s40 offen nt
  s_add_u32 s40, s40, 8192
  v_perm_b32 v21, v212, v208, s42
  v_perm_b32 v22, v213, v209, s41
  v_perm_b32 v23, v213, v209, s42
  v_perm_b32 v24, v214, v210, s41
  v_perm_b32 v25, v214, v210, s42
  v_perm_b32 v26, v215, v211, s41
  v_perm_b32 v27, v215, v211, s42
  v_dot2c_f32_bf16_dpp v8, v48, v20 row_newbcast:4 row_mask:0xf bank_mask:0xf
  v_dot2c_f32_bf16_dpp v9, v48, v21 row_newbcast:4 row_mask:0xf bank_mask:0xf
  s_waitcnt vmcnt(7)
  buffer_load_dwordx4 v[156:159], v44, s[32:35], s40 offen nt
  s_add_u32 s40, s40, 8192
  v_dot2c_f32_bf16_dpp v10, v48, v22 row_newbcast:4 row_mask:0xf bank_mask:0xf
  v_dot2c_f32_bf16_dpp v11, v48, v23 row_newbcast:4 row_mask:0xf bank_mask:0xf
  v_dot2c_f32_bf16_dpp v12, v48, v24 row_newbcast:4 row_mask:0xf bank_mask:0xf
  v_dot2c_f32_bf16_dpp v13, v48, v25 row_newbcast:4 row_mask:0xf bank_mask:0xf
  v_dot2c_f32_bf16_dpp v14, v48, v26 row_newbcast:4 row_mask:0xf bank_mask:0xf
  v_dot2c_f32_bf16_dpp v15, v48, v27 row_newbcast:4 row_mask:0xf bank_mask:0xf
  v_perm_b32 v20, v220, v216, s41
  v_perm_b32 v21, v220, v216, s42
  s_waitcnt vmcnt(7)
  buffer_load_dwordx4 v[160:163], v44, s[32:35], s40 offen nt
  s_add_u32 s40, s40, 8192
  v_perm_b32 v22, v221, v217, s41
  v_perm_b32 v23, v221, v217, s42
  v_perm_b32 v24, v222, v218, s41
  v_perm_b32 v25, v222, v218, s42
  v_perm_b32 v26, v223, v219, s41
  v_perm_b32 v27, v223, v219, s42
  v_dot2c_f32_bf16_dpp v8, v48, v20 row_newbcast:12 row_mask:0xf bank_mask:0xf
  v_dot2c_f32_bf16_dpp v9, v48, v21 row_newbcast:12 row_mask:0xf bank_mask:0xf
  s_waitcnt vmcnt(7)
  buffer_load_dwordx4 v[164:167], v44, s[32:35], s40 offen nt
  s_add_u32 s40, s40, 8192
  v_dot2c_f32_bf16_dpp v10, v48, v22 row_newbcast:12 row_mask:0xf bank_mask:0xf
  v_dot2c_f32_bf16_dpp v11, v48, v23 row_newbcast:12 row_mask:0xf bank_mask:0xf
  v_dot2c_f32_bf16_dpp v12, v48, v24 row_newbcast:12 row_mask:0xf bank_mask:0xf
  v_dot2c_f32_bf16_dpp v13, v48, v25 row_newbcast:12 row_mask:0xf bank_mask:0xf
  v_dot2c_f32_bf16_dpp v14, v48, v26 row_newbcast:12 row_mask:0xf bank_mask:0xf
  v_dot2c_f32_bf16_dpp v15, v48, v27 row_newbcast:12 row_mask:0xf bank_mask:0xf
  v_perm_b32 v20, v228, v224, s41
  v_perm_b32 v21, v228, v224, s42
  s_waitcnt vmcnt(7)
  buffer_load_dwordx4 v[168:171], v44, s[32:35], s40 offen nt
  s_add_u32 s40, s40, 8192
  v_perm_b32 v22, v229, v225, s41
  v_perm_b32 v23, v229, v225, s42
  v_perm_b32 v24, v230, v226, s41
  v_perm_b32 v25, v230, v226, s42
  v_perm_b32 v26, v231, v227, s41
  v_perm_b32 v27, v231, v227, s42
  v_dot2c_f32_bf16_dpp v8, v48, v20 row_newbcast:1 row_mask:0xf bank_mask:0xf
  v_dot2c_f32_bf16_dpp v9, v48, v21 row_newbcast:1 row_mask:0xf bank_mask:0xf
  s_waitcnt vmcnt(7)
  buffer_load_dwordx4 v[172:175], v44, s[32:35], s40 offen nt
  s_add_u32 s40, s40, 8192
  v_dot2c_f32_bf16_dpp v10, v48, v22 row_newbcast:1 row_mask:0xf bank_mask:0xf
  v_dot2c_f32_bf16_dpp v11, v48, v23 row_newbcast:1 row_mask:0xf bank_mask:0xf
  v_dot2c_f32_bf16_dpp v12, v48, v24 row_newbcast:1 row_mask:0xf bank_mask:0xf
  v_dot2c_f32_bf16_dpp v13, v48, v25 row_newbcast:1 row_mask:0xf bank_mask:0xf
  v_dot2c_f32_bf16_dpp v14, v48, v26 row_newbcast:1 row_mask:0xf bank_mask:0xf
  v_dot2c_f32_bf16_dpp v15, v48, v27 row_newbcast:1 row_mask:0xf bank_mask:0xf
  v_perm_b32 v20, v236, v232, s41
  v_perm_b32 v21, v236, v232, s42
  v_perm_b32 v22, v237, v233, s41
  s_waitcnt vmcnt(7)
  buffer_load_dwordx4 v[176:179], v44, s[32:35], s40 offen nt
  s_add_u32 s40, s40, 8192
  v_perm_b32 v23, v237, v233, s42
  v_perm_b32 v24, v238, v234, s41
  v_perm_b32 v25, v238, v234, s42
  v_perm_b32 v26, v239, v235, s41
  v_perm_b32 v27, v239, v235, s42
  v_dot2c_f32_bf16_dpp v8, v48, v20 row_newbcast:9 row_mask:0xf bank_mask:0xf
  v_dot2c_f32_bf16_dpp v9, v48, v21 row_newbcast:9 row_mask:0xf bank_mask:0xf
  v_dot2c_f32_bf16_dpp v10, v48, v22 row_newbcast:9 row_mask:0xf bank_mask:0xf
  s_waitcnt vmcnt(7)
  buffer_load_dwordx4 v[180:183], v44, s[32:35], s40 offen nt
  s_add_u32 s40, s40, 8192
  v_dot2c_f32_bf16_dpp v11, v48, v23 row_newbcast:9 row_mask:0xf bank_mask:0xf
  v_dot2c_f32_bf16_dpp v12, v48, v24 row_newbcast:9 row_mask:0xf bank_mask:0xf
  v_dot2c_f32_bf16_dpp v13, v48, v25 row_newbcast:9 row_mask:0xf bank_mask:0xf
  v_dot2c_f32_bf16_dpp v14, v48, v26 row_newbcast:9 row_mask:0xf bank_mask:0xf
  v_dot2c_f32_bf16_dpp v15, v48, v27 row_newbcast:9 row_mask:0xf bank_mask:0xf
  v_perm_b32 v20, v244, v240, s41
  v_perm_b32 v21, v244, v240, s42
  v_perm_b32 v22, v245, v241, s41
  s_waitcnt vmcnt(7)
  buffer_load_dwordx4 v[184:187], v44, s[32:35], s40 offen nt
  s_add_u32 s40, s40, 8192
  v_perm_b32 v23, v245, v241, s42
  v_perm_b32 v24, v246, v242, s41
  v_perm_b32 v25, v246, v242, s42
  v_perm_b32 v26, v247, v243, s41
  v_perm_b32 v27, v247, v243, s42
  v_dot2c_f32_bf16_dpp v8, v48, v20 row_newbcast:5 row_mask:0xf bank_mask:0xf
  v_dot2c_f32_bf16_dpp v9, v48, v21 row_newbcast:5 row_mask:0xf bank_mask:0xf
  v_dot2c_f32_bf16_dpp v10, v48, v22 row_newbcast:5 row_mask:0xf bank_mask:0xf
  s_waitcnt vmcnt(7)
  buffer_load_dwordx4 v[188:191], v44, s[32:35], s40 offen nt
  s_add_u32 s40, s40, 8192
  v_dot2c_f32_bf16_dpp v11, v48, v23 row_newbcast:5 row_mask:0xf bank_mask:0xf
  v_dot2c_f32_bf16_dpp v12, v48, v24 row_newbcast:5 row_mask:0xf bank_mask:0xf
  v_dot2c_f32_bf16_dpp v13, v48, v25 row_newbcast:5 row_mask:0xf bank_mask:0xf
  v_dot2c_f32_bf16_dpp v14, v48, v26 row_newbcast:5 row_mask:0xf bank_mask:0xf
  v_dot2c_f32_bf16_dpp v15, v48, v27 row_newbcast:5 row_mask:0xf bank_mask:0xf
  v_perm_b32 v20, v252, v248, s41
  v_perm_b32 v21, v252, v248, s42
  v_perm_b32 v22, v253, v249, s41
  v_perm_b32 v23, v253, v249, s42
  s_waitcnt vmcnt(7)
  buffer_load_dwordx4 v[192:195], v44, s[32:35], s40 offen nt
  s_add_u32 s40, s40, 8192
  v_perm_b32 v24, v254, v250, s41
  v_perm_b32 v25, v254, v250, s42
  v_perm_b32 v26, v255, v251, s41
  v_perm_b32 v27, v255, v251, s42
  v_dot2c_f32_bf16_dpp v8, v48, v20 row_newbcast:13 row_mask:0xf bank_mask:0xf
  v_dot2c_f32_bf16_dpp v9, v48, v21 row_newbcast:13 row_mask:0xf bank_mask:0xf
  v_dot2c_f32_bf16_dpp v10, v48, v22 row_newbcast:13 row_mask:0xf bank_mask:0xf
  v_dot2c_f32_bf16_dpp v11, v48, v23 row_newbcast:13 row_mask:0xf bank_mask:0xf
  s_waitcnt vmcnt(7)
  buffer_load_dwordx4 v[196:199], v44, s[32:35], s40 offen nt
  s_add_u32 s40, s40, 8192
  v_dot2c_f32_bf16_dpp v12, v48, v24 row_newbcast:13 row_mask:0xf bank_mask:0xf
  v_dot2c_f32_bf16_dpp v13, v48, v25 row_newbcast:13 row_mask:0xf bank_mask:0xf
  v_dot2c_f32_bf16_dpp v14, v48, v26 row_newbcast:13 row_mask:0xf bank_mask:0xf
  v_dot2c_f32_bf16_dpp v15, v48, v27 row_newbcast:13 row_mask:0xf bank_mask:0xf
  v_perm_b32 v20, v132, v128, s41
  v_perm_b32 v21, v132, v128, s42
  v_perm_b32 v22, v133, v129, s41
  v_perm_b32 v23, v133, v129, s42
  s_waitcnt vmcnt(7)
  buffer_load_dwordx4 v[200:203], v44, s[32:35], s40 offen nt
  s_add_u32 s40, s40, 8192
  v_perm_b32 v24, v134, v130, s41
  v_perm_b32 v25, v134, v130, s42
  v_perm_b32 v26, v135, v131, s41
  v_perm_b32 v27, v135, v131, s42
  v_dot2c_f32_bf16_dpp v8, v48, v20 row_newbcast:2 row_mask:0xf bank_mask:0xf
  v_dot2c_f32_bf16_dpp v9, v48, v21 row_newbcast:2 row_mask:0xf bank_mask:0xf
  v_dot2c_f32_bf16_dpp v10, v48, v22 row_newbcast:2 row_mask:0xf bank_mask:0xf
  v_dot2c_f32_bf16_dpp v11, v48, v23 row_newbcast:2 row_mask:0xf bank_mask:0xf
  s_waitcnt vmcnt(7)
  buffer_load_dwordx4 v[204:207], v44, s[32:35], s40 offen nt
  s_add_u32 s40, s40, 8192
  v_dot2c_f32_bf16_dpp v12, v48, v24 row_newbcast:2 row_mask:0xf bank_mask:0xf
  v_dot2c_f32_bf16_dpp v13, v48, v25 row_newbcast:2 row_mask:0xf bank_mask:0xf
  v_dot2c_f32_bf16_dpp v14, v48, v26 row_newbcast:2 row_mask:0xf bank_mask:0xf
  v_dot2c_f32_bf16_dpp v15, v48, v27 row_newbcast:2 row_mask:0xf bank_mask:0xf
  v_perm_b32 v20, v140, v136, s41
  v_perm_b32 v21, v140, v136, s42
  v_perm_b32 v22, v141, v137, s41
  v_perm_b32 v23, v141, v137, s42
  s_waitcnt vmcnt(7)
  buffer_load_dwordx4 v[208:211], v44, s[32:35], s40 offen nt
  s_add_u32 s40, s40, 8192
  v_perm_b32 v24, v142, v138, s41
  v_perm_b32 v25, v142, v138, s42
  v_perm_b32 v26, v143, v139, s41
  v_perm_b32 v27, v143, v139, s42
  v_dot2c_f32_bf16_dpp v8, v48, v20 row_newbcast:10 row_mask:0xf bank_mask:0xf
  v_dot2c_f32_bf16_dpp v9, v48, v21 row_newbcast:10 row_mask:0xf bank_mask:0xf
  v_dot2c_f32_bf16_dpp v10, v48, v22 row_newbcast:10 row_mask:0xf bank_mask:0xf
  v_dot2c_f32_bf16_dpp v11, v48, v23 row_newbcast:10 row_mask:0xf bank_mask:0xf
  v_dot2c_f32_bf16_dpp v12, v48, v24 row_newbcast:10 row_mask:0xf bank_mask:0xf
  s_waitcnt vmcnt(7)
  buffer_load_dwordx4 v[212:215], v44, s[32:35], s40 offen nt
  s_add_u32 s40, s40, 8192
  v_dot2c_f32_bf16_dpp v13, v48, v25 row_newbcast:10 row_mask:0xf bank_mask:0xf
  v_dot2c_f32_bf16_dpp v14, v48, v26 row_newbcast:10 row_mask:0xf bank_mask:0xf
  v_dot2c_f32_bf16_dpp v15, v48, v27 row_newbcast:10 row_mask:0xf bank_mask:0xf
  v_perm_b32 v20, v148, v144, s41
  v_perm_b32 v21, v148, v144, s42
  v_perm_b32 v22, v149, v145, s41
  v_perm_b32 v23, v149, v145, s42
  v_perm_b32 v24, v150, v146, s41
  s_waitcnt vmcnt(7)
  buffer_load_dwordx4 v[216:219], v44, s[32:35], s40 offen nt
  s_add_u32 s40, s40, 8192
  v_perm_b32 v25, v150, v146, s42
  v_perm_b32 v26, v151, v147, s41
  v_perm_b32 v27, v151, v147, s42
  v_dot2c_f32_bf16_dpp v8, v48, v20 row_newbcast:6 row_mask:0xf bank_mask:0xf
  v_dot2c_f32_bf16_dpp v9, v48, v21 row_newbcast:6 row_mask:0xf bank_mask:0xf
  v_dot2c_f32_bf16_dpp v10, v48, v22 row_newbcast:6 row_mask:0xf bank_mask:0xf
  v_dot2c_f32_bf16_dpp v11, v48, v23 row_newbcast:6 row_mask:0xf bank_mask:0xf
  v_dot2c_f32_bf16_dpp v12, v48, v24 row_newbcast:6 row_mask:0xf bank_mask:0xf
  s_waitcnt vmcnt(7)
  buffer_load_dwordx4 v[220:223], v44, s[32:35], s40 offen nt
  s_add_u32 s40, s40, 8192
  v_dot2c_f32_bf16_dpp v13, v48, v25 row_newbcast:6 row_mask:0xf bank_mask:0xf
  v_dot2c_f32_bf16_dpp v14, v48, v26 row_newbcast:6 row_mask:0xf bank_mask:0xf
  v_dot2c_f32_bf16_dpp v15, v48, v27 row_newbcast:6 row_mask:0xf bank_mask:0xf
  v_perm_b32 v20, v156, v152, s41
  v_perm_b32 v21, v156, v152, s42
  v_perm_b32 v22, v157, v153, s41
  v_perm_b32 v23, v157, v153, s42
  v_perm_b32 v24, v158, v154, s41
  s_waitcnt vmcnt(7)
  buffer_load_dwordx4 v[224:227], v44, s[32:35], s40 offen nt
  s_add_u32 s40, s40, 8192
  v_perm_b32 v25, v158, v154, s42
  v_perm_b32 v26, v159, v155, s41
  v_perm_b32 v27, v159, v155, s42
  v_dot2c_f32_bf16_dpp v8, v48, v20 row_newbcast:14 row_mask:0xf bank_mask:0xf
  v_dot2c_f32_bf16_dpp v9, v48, v21 row_newbcast:14 row_mask:0xf bank_mask:0xf
  v_dot2c_f32_bf16_dpp v10, v48, v22 row_newbcast:14 row_mask:0xf bank_mask:0xf
  v_dot2c_f32_bf16_dpp v11, v48, v23 row_newbcast:14 row_mask:0xf bank_mask:0xf
  v_dot2c_f32_bf16_dpp v12, v48, v24 row_newbcast:14 row_mask:0xf bank_mask:0xf
  v_dot2c_f32_bf16_dpp v13, v48, v25 row_newbcast:14 row_mask:0xf bank_mask:0xf
  s_waitcnt vmcnt(7)
  buffer_load_dwordx4 v[228:231], v44, s[32:35], s40 offen nt
  s_add_u32 s40, s40, 8192
  v_dot2c_f32_bf16_dpp v14, v48, v26 row_newbcast:14 row_mask:0xf bank_mask:0xf
  v_dot2c_f32_bf16_dpp v15, v48, v27 row_newbcast:14 row_mask:0xf bank_mask:0xf
  v_perm_b32 v20, v164, v160, s41
  v_perm_b32 v21, v164, v160, s42
  v_perm_b32 v22, v165, v161, s41
  v_perm_b32 v23, v165, v161, s42
  v_perm_b32 v24, v166, v162, s41
  v_perm_b32 v25, v166, v162, s42
  s_waitcnt vmcnt(7)
  buffer_load_dwordx4 v[232:235], v44, s[32:35], s40 offen nt
  s_add_u32 s40, s40, 8192
  v_perm_b32 v26, v167, v163, s41
  v_perm_b32 v27, v167, v163, s42
  v_dot2c_f32_bf16_dpp v8, v48, v20 row_newbcast:3 row_mask:0xf bank_mask:0xf
  v_dot2c_f32_bf16_dpp v9, v48, v21 row_newbcast:3 row_mask:0xf bank_mask:0xf
  v_dot2c_f32_bf16_dpp v10, v48, v22 row_newbcast:3 row_mask:0xf bank_mask:0xf
  v_dot2c_f32_bf16_dpp v11, v48, v23 row_newbcast:3 row_mask:0xf bank_mask:0xf
  v_dot2c_f32_bf16_dpp v12, v48, v24 row_newbcast:3 row_mask:0xf bank_mask:0xf
  v_dot2c_f32_bf16_dpp v13, v48, v25 row_newbcast:3 row_mask:0xf bank_mask:0xf
  s_waitcnt vmcnt(7)
  buffer_load_dwordx4 v[236:239], v44, s[32:35], s40 offen nt
  s_add_u32 s40, s40, 8192
  v_dot2c_f32_bf16_dpp v14, v48, v26 row_newbcast:3 row_mask:0xf bank_mask:0xf
  v_dot2c_f32_bf16_dpp v15, v48, v27 row_newbcast:3 row_mask:0xf bank_mask:0xf
  v_perm_b32 v20, v172, v168, s41
  v_perm_b32 v21, v172, v168, s42
  v_perm_b32 v22, v173, v169, s41
  v_perm_b32 v23, v173, v169, s42
  v_perm_b32 v24, v174, v170, s41
  v_perm_b32 v25, v174, v170, s42
  s_waitcnt vmcnt(7)
  buffer_load_dwordx4 v[240:243], v44, s[32:35], s40 offen nt
  s_add_u32 s40, s40, 8192
  v_perm_b32 v26, v175, v171, s41
  v_perm_b32 v27, v175, v171, s42
  v_dot2c_f32_bf16_dpp v8, v48, v20 row_newbcast:11 row_mask:0xf bank_mask:0xf
  v_dot2c_f32_bf16_dpp v9, v48, v21 row_newbcast:11 row_mask:0xf bank_mask:0xf
  v_dot2c_f32_bf16_dpp v10, v48, v22 row_newbcast:11 row_mask:0xf bank_mask:0xf
  v_dot2c_f32_bf16_dpp v11, v48, v23 row_newbcast:11 row_mask:0xf bank_mask:0xf
  v_dot2c_f32_bf16_dpp v12, v48, v24 row_newbcast:11 row_mask:0xf bank_mask:0xf
  v_dot2c_f32_bf16_dpp v13, v48, v25 row_newbcast:11 row_mask:0xf bank_mask:0xf
  s_waitcnt vmcnt(7)
  buffer_load_dwordx4 v[244:247], v44, s[32:35], s40 offen nt
  s_add_u32 s40, s40, 8192
  v_dot2c_f32_bf16_dpp v14, v48, v26 row_newbcast:11 row_mask:0xf bank_mask:0xf
  v_dot2c_f32_bf16_dpp v15, v48, v27 row_newbcast:11 row_mask:0xf bank_mask:0xf
  v_perm_b32 v20, v180, v176, s41
  v_perm_b32 v21, v180, v176, s42
  v_perm_b32 v22, v181, v177, s41
  v_perm_b32 v23, v181, v177, s42
  v_perm_b32 v24, v182, v178, s41
  v_perm_b32 v25, v182, v178, s42
  v_perm_b32 v26, v183, v179, s41
  s_waitcnt vmcnt(7)
  buffer_load_dwordx4 v[248:251], v44, s[32:35], s40 offen nt
  s_add_u32 s40, s40, 8192
  v_perm_b32 v27, v183, v179, s42
  v_dot2c_f32_bf16_dpp v8, v48, v20 row_newbcast:7 row_mask:0xf bank_mask:0xf
  v_dot2c_f32_bf16_dpp v9, v48, v21 row_newbcast:7 row_mask:0xf bank_mask:0xf
  v_dot2c_f32_bf16_dpp v10, v48, v22 row_newbcast:7 row_mask:0xf bank_mask:0xf
  v_dot2c_f32_bf16_dpp v11, v48, v23 row_newbcast:7 row_mask:0xf bank_mask:0xf
  v_dot2c_f32_bf16_dpp v12, v48, v24 row_newbcast:7 row_mask:0xf bank_mask:0xf
  v_dot2c_f32_bf16_dpp v13, v48, v25 row_newbcast:7 row_mask:0xf bank_mask:0xf
  v_dot2c_f32_bf16_dpp v14, v48, v26 row_newbcast:7 row_mask:0xf bank_mask:0xf
  s_waitcnt vmcnt(7)
  buffer_load_dwordx4 v[252:255], v44, s[32:35], s40 offen nt
  s_add_u32 s40, s40, 8192
  v_dot2c_f32_bf16_dpp v15, v48, v27 row_newbcast:7 row_mask:0xf bank_mask:0xf
  v_perm_b32 v20, v188, v184, s41
  v_perm_b32 v21, v188, v184, s42
  v_perm_b32 v22, v189, v185, s41
  v_perm_b32 v23, v189, v185, s42
  v_perm_b32 v24, v190, v186, s41
  v_perm_b32 v25, v190, v186, s42
  v_perm_b32 v26, v191, v187, s41
  s_waitcnt vmcnt(7)
  buffer_load_dwordx4 v[128:131], v44, s[32:35], s40 offen nt
  s_add_u32 s40, s40, 8192
  v_perm_b32 v27, v191, v187, s42
  v_dot2c_f32_bf16_dpp v8, v48, v20 row_newbcast:15 row_mask:0xf bank_mask:0xf
  v_dot2c_f32_bf16_dpp v9, v48, v21 row_newbcast:15 row_mask:0xf bank_mask:0xf
  v_dot2c_f32_bf16_dpp v10, v48, v22 row_newbcast:15 row_mask:0xf bank_mask:0xf
  v_dot2c_f32_bf16_dpp v11, v48, v23 row_newbcast:15 row_mask:0xf bank_mask:0xf
  v_dot2c_f32_bf16_dpp v12, v48, v24 row_newbcast:15 row_mask:0xf bank_mask:0xf
  v_dot2c_f32_bf16_dpp v13, v48, v25 row_newbcast:15 row_mask:0xf bank_mask:0xf
  v_dot2c_f32_bf16_dpp v14, v48, v26 row_newbcast:15 row_mask:0xf bank_mask:0xf
  s_waitcnt vmcnt(7)
  buffer_load_dwordx4 v[132:135], v44, s[32:35], s40 offen nt
  s_add_u32 s40, s40, 8192
  v_dot2c_f32_bf16_dpp v15, v48, v27 row_newbcast:15 row_mask:0xf bank_mask:0xf
  v_mov_b32 v48, v49
  v_mov_b32 v49, v50
  v_mov_b32 v50, v51
  v_mov_b32 v51, v52
  v_mov_b32 v52, v53
  v_mov_b32 v53, v54
  v_mov_b32 v54, v55
  s_sub_u32 s55, s55, 1
  s_cmp_lg_u32 s55, 0
  s_cbranch_scc1 L_vloopE
  s_waitcnt vmcnt(7)
  buffer_load_dwordx4 v[136:139], v44, s[32:35], s40 offen nt
  s_add_u32 s40, s40, 8192
  v_perm_b32 v20, v196, v192, s41
  v_perm_b32 v21, v196, v192, s42
  v_perm_b32 v22, v197, v193, s41
  v_perm_b32 v23, v197, v193, s42
  v_perm_b32 v24, v198, v194, s41
  v_perm_b32 v25, v198, v194, s42
  v_perm_b32 v26, v199, v195, s41
  v_perm_b32 v27, v199, v195, s42
  s_waitcnt vmcnt(7)
  buffer_load_dwordx4 v[140:143], v44, s[32:35], s40 offen nt
  s_add_u32 s40, s40, 8192
  v_dot2c_f32_bf16_dpp v8, v48, v20 row_newbcast:0 row_mask:0xf bank_mask:0xf
  v_dot2c_f32_bf16_dpp v9, v48, v21 row_newbcast:0 row_mask:0xf bank_mask:0xf
  v_dot2c_f32_bf16_dpp v10, v48, v22 row_newbcast:0 row_mask:0xf bank_mask:0xf
  v_dot2c_f32_bf16_dpp v11, v48, v23 row_newbcast:0 row_mask:0xf bank_mask:0xf
  v_dot2c_f32_bf16_dpp v12, v48, v24 row_newbcast:0 row_mask:0xf bank_mask:0xf
  v_dot2c_f32_bf16_dpp v13, v48, v25 row_newbcast:0 row_mask:0xf bank_mask:0xf
  v_dot2c_f32_bf16_dpp v14, v48, v26 row_newbcast:0 row_mask:0xf bank_mask:0xf
  v_dot2c_f32_bf16_dpp v15, v48, v27 row_newbcast:0 row_mask:0xf bank_mask:0xf
  s_waitcnt vmcnt(7)
  buffer_load_dwordx4 v[144:147], v44, s[32:35], s40 offen nt
  s_add_u32 s40, s40, 8192
  v_perm_b32 v20, v204, v200, s41
  v_perm_b32 v21, v204, v200, s42
  v_perm_b32 v22, v205, v201, s41
  v_perm_b32 v23, v205, v201, s42
  v_perm_b32 v24, v206, v202, s41
  v_perm_b32 v25, v206, v202, s42
  v_perm_b32 v26, v207, v203, s41
  v_perm_b32 v27, v207, v203, s42
  s_waitcnt vmcnt(7)
  buffer_load_dwordx4 v[148:151], v44, s[32:35], s40 offen nt
  s_add_u32 s40, s40, 8192
  v_dot2c_f32_bf16_dpp v8, v48, v20 row_newbcast:8 row_mask:0xf bank_mask:0xf
  v_dot2c_f32_bf16_dpp v9, v48, v21 row_newbcast:8 row_mask:0xf bank_mask:0xf
  v_dot2c_f32_bf16_dpp v10, v48, v22 row_newbcast:8 row_mask:0xf bank_mask:0xf
  v_dot2c_f32_bf16_dpp v11, v48, v23 row_newbcast:8 row_mask:0xf bank_mask:0xf
  v_dot2c_f32_bf16_dpp v12, v48, v24 row_newbcast:8 row_mask:0xf bank_mask:0xf
  v_dot2c_f32_bf16_dpp v13, v48, v25 row_newbcast:8 row_mask:0xf bank_mask:0xf
  v_dot2c_f32_bf16_dpp v14, v48, v26 row_newbcast:8 row_mask:0xf bank_mask:0xf
  v_dot2c_f32_bf16_dpp v15, v48, v27 row_newbcast:8 row_mask:0xf bank_mask:0xf
  s_waitcnt vmcnt(7)
  buffer_load_dwordx4 v[152:155], v44, s[32:35], s40 offen nt
  s_add_u32 s40, s40, 8192
  v_perm_b32 v20, v212, v208, s41
  v_perm_b32 v21, v212, v208, s42
  v_perm_b32 v22, v213, v209, s41
  v_perm_b32 v23, v213, v209, s42
  v_perm_b32 v24, v214, v210, s41
  v_perm_b32 v25, v214, v210, s42
  v_perm_b32 v26, v215, v211, s41
  v_perm_b32 v27, v215, v211, s42
  s_waitcnt vmcnt(7)
  buffer_load_dwordx4 v[156:159], v44, s[32:35], s40 offen nt
  s_add_u32 s40, s40, 8192
  v_dot2c_f32_bf16_dpp v8, v48, v20 row_newbcast:4 row_mask:0xf bank_mask:0xf
  v_dot2c_f32_bf16_dpp v9, v48, v21 row_newbcast:4 row_mask:0xf bank_mask:0xf
  v_dot2c_f32_bf16_dpp v10, v48, v22 row_newbcast:4 row_mask:0xf bank_mask:0xf
  v_dot2c_f32_bf16_dpp v11, v48, v23 row_newbcast:4 row_mask:0xf bank_mask:0xf
  v_dot2c_f32_bf16_dpp v12, v48, v24 row_newbcast:4 row_mask:0xf bank_mask:0xf
  v_dot2c_f32_bf16_dpp v13, v48, v25 row_newbcast:4 row_mask:0xf bank_mask:0xf
  v_dot2c_f32_bf16_dpp v14, v48, v26 row_newbcast:4 row_mask:0xf bank_mask:0xf
  v_dot2c_f32_bf16_dpp v15, v48, v27 row_newbcast:4 row_mask:0xf bank_mask:0xf
  s_waitcnt vmcnt(7)
  buffer_load_dwordx4 v[160:163], v44, s[32:35], s40 offen nt
  s_add_u32 s40, s40, 8192
  v_perm_b32 v20, v220, v216, s41
  v_perm_b32 v21, v220, v216, s42
  v_perm_b32 v22, v221, v217, s41
  v_perm_b32 v23, v221, v217, s42
  v_perm_b32 v24, v222, v218, s41
  v_perm_b32 v25, v222, v218, s42
  v_perm_b32 v26, v223, v219, s41
  v_perm_b32 v27, v223, v219, s42
  s_waitcnt vmcnt(7)
  buffer_load_dwordx4 v[164:167], v44, s[32:35], s40 offen nt
  s_add_u32 s40, s40, 8192
  v_dot2c_f32_bf16_dpp v8, v48, v20 row_newbcast:12 row_mask:0xf bank_mask:0xf
  v_dot2c_f32_bf16_dpp v9, v48, v21 row_newbcast:12 row_mask:0xf bank_mask:0xf
  v_dot2c_f32_bf16_dpp v10, v48, v22 row_newbcast:12 row_mask:0xf bank_mask:0xf
  v_dot2c_f32_bf16_dpp v11, v48, v23 row_newbcast:12 row_mask:0xf bank_mask:0xf
  v_dot2c_f32_bf16_dpp v12, v48, v24 row_newbcast:12 row_mask:0xf bank_mask:0xf
  v_dot2c_f32_bf16_dpp v13, v48, v25 row_newbcast:12 row_mask:0xf bank_mask:0xf
  v_dot2c_f32_bf16_dpp v14, v48, v26 row_newbcast:12 row_mask:0xf bank_mask:0xf
  v_dot2c_f32_bf16_dpp v15, v48, v27 row_newbcast:12 row_mask:0xf bank_mask:0xf
  s_waitcnt vmcnt(7)
  buffer_load_dwordx4 v[168:171], v44, s[32:35], s40 offen nt
  s_add_u32 s40, s40, 8192
  v_perm_b32 v20, v228, v224, s41
  v_perm_b32 v21, v228, v224, s42
  v_perm_b32 v22, v229, v225, s41
  v_perm_b32 v23, v229, v225, s42
  v_perm_b32 v24, v230, v226, s41
  v_perm_b32 v25, v230, v226, s42
  v_perm_b32 v26, v231, v227, s41
  v_perm_b32 v27, v231, v227, s42
  s_waitcnt vmcnt(7)
  buffer_load_dwordx4 v[172:175], v44, s[32:35], s40 offen nt
  s_add_u32 s40, s40, 8192
  v_dot2c_f32_bf16_dpp v8, v48, v20 row_newbcast:1 row_mask:0xf bank_mask:0xf
  v_dot2c_f32_bf16_dpp v9, v48, v21 row_newbcast:1 row_mask:0xf bank_mask:0xf
  v_dot2c_f32_bf16_dpp v10, v48, v22 row_newbcast:1 row_mask:0xf bank_mask:0xf
  v_dot2c_f32_bf16_dpp v11, v48, v23 row_newbcast:1 row_mask:0xf bank_mask:0xf
  v_dot2c_f32_bf16_dpp v12, v48, v24 row_newbcast:1 row_mask:0xf bank_mask:0xf
  v_dot2c_f32_bf16_dpp v13, v48, v25 row_newbcast:1 row_mask:0xf bank_mask:0xf
  v_dot2c_f32_bf16_dpp v14, v48, v26 row_newbcast:1 row_mask:0xf bank_mask:0xf
  v_dot2c_f32_bf16_dpp v15, v48, v27 row_newbcast:1 row_mask:0xf bank_mask:0xf
  s_waitcnt vmcnt(7)
  buffer_load_dwordx4 v[176:179], v44, s[32:35], s40 offen nt
  s_add_u32 s40, s40, 8192
  v_perm_b32 v20, v236, v232, s41
  v_perm_b32 v21, v236, v232, s42
  v_perm_b32 v22, v237, v233, s41
  v_perm_b32 v23, v237, v233, s42
  v_perm_b32 v24, v238, v234, s41
  v_perm_b32 v25, v238, v234, s42
  v_perm_b32 v26, v239, v235, s41
  v_perm_b32 v27, v239, v235, s42
  s_waitcnt vmcnt(7)
  buffer_load_dwordx4 v[180:183], v44, s[32:35], s40 offen nt
  s_add_u32 s40, s40, 8192
  v_dot2c_f32_bf16_dpp v8, v48, v20 row_newbcast:9 row_mask:0xf bank_mask:0xf
  v_dot2c_f32_bf16_dpp v9, v48, v21 row_newbcast:9 row_mask:0xf bank_mask:0xf
  v_dot2c_f32_bf16_dpp v10, v48, v22 row_newbcast:9 row_mask:0xf bank_mask:0xf
  v_dot2c_f32_bf16_dpp v11, v48, v23 row_newbcast:9 row_mask:0xf bank_mask:0xf
  v_dot2c_f32_bf16_dpp v12, v48, v24 row_newbcast:9 row_mask:0xf bank_mask:0xf
  v_dot2c_f32_bf16_dpp v13, v48, v25 row_newbcast:9 row_mask:0xf bank_mask:0xf
  v_dot2c_f32_bf16_dpp v14, v48, v26 row_newbcast:9 row_mask:0xf bank_mask:0xf
  v_dot2c_f32_bf16_dpp v15, v48, v27 row_newbcast:9 row_mask:0xf bank_mask:0xf
  s_waitcnt vmcnt(7)
  buffer_load_dwordx4 v[184:187], v44, s[32:35], s40 offen nt
  s_add_u32 s40, s40, 8192
  v_perm_b32 v20, v244, v240, s41
  v_perm_b32 v21, v244, v240, s42
  v_perm_b32 v22, v245, v241, s41
  v_perm_b32 v23, v245, v241, s42
  v_perm_b32 v24, v246, v242, s41
  v_perm_b32 v25, v246, v242, s42
  v_perm_b32 v26, v247, v243, s41
  v_perm_b32 v27, v247, v243, s42
  s_waitcnt vmcnt(7)
  buffer_load_dwordx4 v[188:191], v44, s[32:35], s40 offen nt
  s_add_u32 s40, s40, 8192
  v_dot2c_f32_bf16_dpp v8, v48, v20 row_newbcast:5 row_mask:0xf bank_mask:0xf
  v_dot2c_f32_bf16_dpp v9, v48, v21 row_newbcast:5 row_mask:0xf bank_mask:0xf
  v_dot2c_f32_bf16_dpp v10, v48, v22 row_newbcast:5 row_mask:0xf bank_mask:0xf
  v_dot2c_f32_bf16_dpp v11, v48, v23 row_newbcast:5 row_mask:0xf bank_mask:0xf
  v_dot2c_f32_bf16_dpp v12, v48, v24 row_newbcast:5 row_mask:0xf bank_mask:0xf
  v_dot2c_f32_bf16_dpp v13, v48, v25 row_newbcast:5 row_mask:0xf bank_mask:0xf
  v_dot2c_f32_bf16_dpp v14, v48, v26 row_newbcast:5 row_mask:0xf bank_mask:0xf
  v_dot2c_f32_bf16_dpp v15, v48, v27 row_newbcast:5 row_mask:0xf bank_mask:0xf
  v_perm_b32 v20, v252, v248, s41
  v_perm_b32 v21, v252, v248, s42
  v_perm_b32 v22, v253, v249, s41
  v_perm_b32 v23, v253, v249, s42
  v_perm_b32 v24, v254, v250, s41
  v_perm_b32 v25, v254, v250, s42
  v_perm_b32 v26, v255, v251, s41
  v_perm_b32 v27, v255, v251, s42
  v_dot2c_f32_bf16_dpp v8, v48, v20 row_newbcast:13 row_mask:0xf bank_mask:0xf
  v_dot2c_f32_bf16_dpp v9, v48, v21 row_newbcast:13 row_mask:0xf bank_mask:0xf
  v_dot2c_f32_bf16_dpp v10, v48, v22 row_newbcast:13 row_mask:0xf bank_mask:0xf
  v_dot2c_f32_bf16_dpp v11, v48, v23 row_newbcast:13 row_mask:0xf bank_mask:0xf
  v_dot2c_f32_bf16_dpp v12, v48, v24 row_newbcast:13 row_mask:0xf bank_mask:0xf
  v_dot2c_f32_bf16_dpp v13, v48, v25 row_newbcast:13 row_mask:0xf bank_mask:0xf
  v_dot2c_f32_bf16_dpp v14, v48, v26 row_newbcast:13 row_mask:0xf bank_mask:0xf
  v_dot2c_f32_bf16_dpp v15, v48, v27 row_newbcast:13 row_mask:0xf bank_mask:0xf
  v_perm_b32 v20, v132, v128, s41
  v_perm_b32 v21, v132, v128, s42
  v_perm_b32 v22, v133, v129, s41
  v_perm_b32 v23, v133, v129, s42
  v_perm_b32 v24, v134, v130, s41
  v_perm_b32 v25, v134, v130, s42
  v_perm_b32 v26, v135, v131, s41
  v_perm_b32 v27, v135, v131, s42
  v_dot2c_f32_bf16_dpp v8, v48, v20 row_newbcast:2 row_mask:0xf bank_mask:0xf
  v_dot2c_f32_bf16_dpp v9, v48, v21 row_newbcast:2 row_mask:0xf bank_mask:0xf
  v_dot2c_f32_bf16_dpp v10, v48, v22 row_newbcast:2 row_mask:0xf bank_mask:0xf
  v_dot2c_f32_bf16_dpp v11, v48, v23 row_newbcast:2 row_mask:0xf bank_mask:0xf
  v_dot2c_f32_bf16_dpp v12, v48, v24 row_newbcast:2 row_mask:0xf bank_mask:0xf
  v_dot2c_f32_bf16_dpp v13, v48, v25 row_newbcast:2 row_mask:0xf bank_mask:0xf
  v_dot2c_f32_bf16_dpp v14, v48, v26 row_newbcast:2 row_mask:0xf bank_mask:0xf
  v_dot2c_f32_bf16_dpp v15, v48, v27 row_newbcast:2 row_mask:0xf bank_mask:0xf
  v_perm_b32 v20, v140, v136, s41
  v_perm_b32 v21, v140, v136, s42
  v_perm_b32 v22, v141, v137, s41
  v_perm_b32 v23, v141, v137, s42
  v_perm_b32 v24, v142, v138, s41
  v_perm_b32 v25, v142, v138, s42
  v_perm_b32 v26, v143, v139, s41
  v_perm_b32 v27, v143, v139, s42
  v_dot2c_f32_bf16_dpp v8, v48, v20 row_newbcast:10 row_mask:0xf bank_mask:0xf
  v_dot2c_f32_bf16_dpp v9, v48, v21 row_newbcast:10 row_mask:0xf bank_mask:0xf
  v_dot2c_f32_bf16_dpp v10, v48, v22 row_newbcast:10 row_mask:0xf bank_mask:0xf
  v_dot2c_f32_bf16_dpp v11, v48, v23 row_newbcast:10 row_mask:0xf bank_mask:0xf
  v_dot2c_f32_bf16_dpp v12, v48, v24 row_newbcast:10 row_mask:0xf bank_mask:0xf
  v_dot2c_f32_bf16_dpp v13, v48, v25 row_newbcast:10 row_mask:0xf bank_mask:0xf
  v_dot2c_f32_bf16_dpp v14, v48, v26 row_newbcast:10 row_mask:0xf bank_mask:0xf
  v_dot2c_f32_bf16_dpp v15, v48, v27 row_newbcast:10 row_mask:0xf bank_mask:0xf
  v_perm_b32 v20, v148, v144, s41
  v_perm_b32 v21, v148, v144, s42
  v_perm_b32 v22, v149, v145, s41
  v_perm_b32 v23, v149, v145, s42
  v_perm_b32 v24, v150, v146, s41
  v_perm_b32 v25, v150, v146, s42
  v_perm_b32 v26, v151, v147, s41
  v_perm_b32 v27, v151, v147, s42
  v_dot2c_f32_bf16_dpp v8, v48, v20 row_newbcast:6 row_mask:0xf bank_mask:0xf
  v_dot2c_f32_bf16_dpp v9, v48, v21 row_newbcast:6 row_mask:0xf bank_mask:0xf
  v_dot2c_f32_bf16_dpp v10, v48, v22 row_newbcast:6 row_mask:0xf bank_mask:0xf
  v_dot2c_f32_bf16_dpp v11, v48, v23 row_newbcast:6 row_mask:0xf bank_mask:0xf
  v_dot2c_f32_bf16_dpp v12, v48, v24 row_newbcast:6 row_mask:0xf bank_mask:0xf
  v_dot2c_f32_bf16_dpp v13, v48, v25 row_newbcast:6 row_mask:0xf bank_mask:0xf
  v_dot2c_f32_bf16_dpp v14, v48, v26 row_newbcast:6 row_mask:0xf bank_mask:0xf
  v_dot2c_f32_bf16_dpp v15, v48, v27 row_newbcast:6 row_mask:0xf bank_mask:0xf
  v_perm_b32 v20, v156, v152, s41
  v_perm_b32 v21, v156, v152, s42
  v_perm_b32 v22, v157, v153, s41
  v_perm_b32 v23, v157, v153, s42
  v_perm_b32 v24, v158, v154, s41
  v_perm_b32 v25, v158, v154, s42
  v_perm_b32 v26, v159, v155, s41
  v_perm_b32 v27, v159, v155, s42
  v_dot2c_f32_bf16_dpp v8, v48, v20 row_newbcast:14 row_mask:0xf bank_mask:0xf
  v_dot2c_f32_bf16_dpp v9, v48, v21 row_newbcast:14 row_mask:0xf bank_mask:0xf
  v_dot2c_f32_bf16_dpp v10, v48, v22 row_newbcast:14 row_mask:0xf bank_mask:0xf
  v_dot2c_f32_bf16_dpp v11, v48, v23 row_newbcast:14 row_mask:0xf bank_mask:0xf
  v_dot2c_f32_bf16_dpp v12, v48, v24 row_newbcast:14 row_mask:0xf bank_mask:0xf
  v_dot2c_f32_bf16_dpp v13, v48, v25 row_newbcast:14 row_mask:0xf bank_mask:0xf
  v_dot2c_f32_bf16_dpp v14, v48, v26 row_newbcast:14 row_mask:0xf bank_mask:0xf
  v_dot2c_f32_bf16_dpp v15, v48, v27 row_newbcast:14 row_mask:0xf bank_mask:0xf
  s_waitcnt vmcnt(6)
  v_perm_b32 v20, v164, v160, s41
  v_perm_b32 v21, v164, v160, s42
  v_perm_b32 v22, v165, v161, s41
  v_perm_b32 v23, v165, v161, s42
  v_perm_b32 v24, v166, v162, s41
  v_perm_b32 v25, v166, v162, s42
  v_perm_b32 v26, v167, v163, s41
  v_perm_b32 v27, v167, v163, s42
  v_dot2c_f32_bf16_dpp v8, v48, v20 row_newbcast:3 row_mask:0xf bank_mask:0xf
  v_dot2c_f32_bf16_dpp v9, v48, v21 row_newbcast:3 row_mask:0xf bank_mask:0xf
  v_dot2c_f32_bf16_dpp v10, v48, v22 row_newbcast:3 row_mask:0xf bank_mask:0xf
  v_dot2c_f32_bf16_dpp v11, v48, v23 row_newbcast:3 row_mask:0xf bank_mask:0xf
  v_dot2c_f32_bf16_dpp v12, v48, v24 row_newbcast:3 row_mask:0xf bank_mask:0xf
  v_dot2c_f32_bf16_dpp v13, v48, v25 row_newbcast:3 row_mask:0xf bank_mask:0xf
  v_dot2c_f32_bf16_dpp v14, v48, v26 row_newbcast:3 row_mask:0xf bank_mask:0xf
  v_dot2c_f32_bf16_dpp v15, v48, v27 row_newbcast:3 row_mask:0xf bank_mask:0xf
  s_waitcnt vmcnt(4)
  v_perm_b32 v20, v172, v168, s41
  v_perm_b32 v21, v172, v168, s42
  v_perm_b32 v22, v173, v169, s41
  v_perm_b32 v23, v173, v169, s42
  v_perm_b32 v24, v174, v170, s41
  v_perm_b32 v25, v174, v170, s42
  v_perm_b32 v26, v175, v171, s41
  v_perm_b32 v27, v175, v171, s42
  v_dot2c_f32_bf16_dpp v8, v48, v20 row_newbcast:11 row_mask:0xf bank_mask:0xf
  v_dot2c_f32_bf16_dpp v9, v48, v21 row_newbcast:11 row_mask:0xf bank_mask:0xf
  v_dot2c_f32_bf16_dpp v10, v48, v22 row_newbcast:11 row_mask:0xf bank_mask:0xf
  v_dot2c_f32_bf16_dpp v11, v48, v23 row_newbcast:11 row_mask:0xf bank_mask:0xf
  v_dot2c_f32_bf16_dpp v12, v48, v24 row_newbcast:11 row_mask:0xf bank_mask:0xf
  v_dot2c_f32_bf16_dpp v13, v48, v25 row_newbcast:11 row_mask:0xf bank_mask:0xf
  v_dot2c_f32_bf16_dpp v14, v48, v26 row_newbcast:11 row_mask:0xf bank_mask:0xf
  v_dot2c_f32_bf16_dpp v15, v48, v27 row_newbcast:11 row_mask:0xf bank_mask:0xf
  s_waitcnt vmcnt(2)
  v_perm_b32 v20, v180, v176, s41
  v_perm_b32 v21, v180, v176, s42
  v_perm_b32 v22, v181, v177, s41
  v_perm_b32 v23, v181, v177, s42
  v_perm_b32 v24, v182, v178, s41
  v_perm_b32 v25, v182, v178, s42
  v_perm_b32 v26, v183, v179, s41
  v_perm_b32 v27, v183, v179, s42
  v_dot2c_f32_bf16_dpp v8, v48, v20 row_newbcast:7 row_mask:0xf bank_mask:0xf
  v_dot2c_f32_bf16_dpp v9, v48, v21 row_newbcast:7 row_mask:0xf bank_mask:0xf
  v_dot2c_f32_bf16_dpp v10, v48, v22 row_newbcast:7 row_mask:0xf bank_mask:0xf
  v_dot2c_f32_bf16_dpp v11, v48, v23 row_newbcast:7 row_mask:0xf bank_mask:0xf
  v_dot2c_f32_bf16_dpp v12, v48, v24 row_newbcast:7 row_mask:0xf bank_mask:0xf
  v_dot2c_f32_bf16_dpp v13, v48, v25 row_newbcast:7 row_mask:0xf bank_mask:0xf
  v_dot2c_f32_bf16_dpp v14, v48, v26 row_newbcast:7 row_mask:0xf bank_mask:0xf
  v_dot2c_f32_bf16_dpp v15, v48, v27 row_newbcast:7 row_mask:0xf bank_mask:0xf
  s_waitcnt vmcnt(0)
  v_perm_b32 v20, v188, v184, s41
  v_perm_b32 v21, v188, v184, s42
  v_perm_b32 v22, v189, v185, s41
  v_perm_b32 v23, v189, v185, s42
  v_perm_b32 v24, v190, v186, s41
  v_perm_b32 v25, v190, v186, s42
  v_perm_b32 v26, v191, v187, s41
  v_perm_b32 v27, v191, v187, s42
  v_dot2c_f32_bf16_dpp v8, v48, v20 row_newbcast:15 row_mask:0xf bank_mask:0xf
  v_dot2c_f32_bf16_dpp v9, v48, v21 row_newbcast:15 row_mask:0xf bank_mask:0xf
  v_dot2c_f32_bf16_dpp v10, v48, v22 row_newbcast:15 row_mask:0xf bank_mask:0xf
  v_dot2c_f32_bf16_dpp v11, v48, v23 row_newbcast:15 row_mask:0xf bank_mask:0xf
  v_dot2c_f32_bf16_dpp v12, v48, v24 row_newbcast:15 row_mask:0xf bank_mask:0xf
  v_dot2c_f32_bf16_dpp v13, v48, v25 row_newbcast:15 row_mask:0xf bank_mask:0xf
  v_dot2c_f32_bf16_dpp v14, v48, v26 row_newbcast:15 row_mask:0xf bank_mask:0xf
  v_dot2c_f32_bf16_dpp v15, v48, v27 row_newbcast:15 row_mask:0xf bank_mask:0xf
  v_cvt_pk_bf16_f32 v20, v8, v9
  v_cvt_pk_bf16_f32 v21, v10, v11
  v_cvt_pk_bf16_f32 v22, v12, v13
  v_cvt_pk_bf16_f32 v23, v14, v15
  ds_write_b128 v46, v[20:23] offset:22528
  s_waitcnt lgkmcnt(0)
  s_barrier
  s_cmp_eq_u32 s88, 4
  s_cbranch_scc1 L_sred
  s_endpgm
L_aux:
  s_mov_b32 s50, 5120
  s_mov_b32 s51, 0x20000
  s_mov_b32 s35, 0x20000
  s_mov_b32 s92, 0
  s_cmp_lg_u32 s3, 0
  s_cbranch_scc1 L_side
  s_and_b32 s46, s29, 3
  v_lshrrev_b32 v4, 2, v3
  v_mul_u32_u24 v4, 1280, v4
  v_lshl_add_u32 v4, v2, 4, v4
  v_and_b32 v5, 3, v3
  v_xor_b32 v5, s46, v5
  v_mul_u32_u24 v5, 320, v5
  v_add_u32 v4, v4, v5
  v_lshlrev_b32 v6, 16, v2
  v_lshl_add_u32 v6, v3, 3, v6
  s_mul_i32 s47, s46, 1310720
  s_lshl_b32 s40, s28, 8
  s_add_u32 s47, s47, s40
  s_lshr_b32 s45, s29, 2
  s_lshl_b32 s40, s45, 7
  s_add_u32 s47, s47, s40
  s_sub_u32 s34, 5242880, s47
  s_waitcnt lgkmcnt(0)
  s_mov_b32 s48, s4
  s_mov_b32 s49, s5
  s_add_u32 s32, s10, s47
  s_addc_u32 s33, s11, 0
  s_load_dword s61, s[26:27], 0
  buffer_load_dwordx4 v[12:15], v4, s[48:51], 0 offen offset:0
  buffer_load_dwordx4 v[16:19], v4, s[48:51], 0 offen offset:64
  buffer_load_dwordx4 v[20:23], v4, s[48:51], 0 offen offset:128
  buffer_load_dwordx4 v[24:27], v4, s[48:51], 0 offen offset:192
  buffer_load_dwordx4 v[28:31], v4, s[48:51], 0 offen offset:256
  s_mov_b32 s40, 0
  buffer_load_dwordx2 v[96:97], v6, s[32:35], s40 offen nt
  s_mov_b32 s40, 8192
  buffer_load_dwordx2 v[98:99], v6, s[32:35], s40 offen nt
  s_mov_b32 s40, 16384
  buffer_load_dwordx2 v[100:101], v6, s[32:35], s40 offen nt
  s_mov_b32 s40, 24576
  buffer_load_dwordx2 v[102:103], v6, s[32:35], s40 offen nt
  s_mov_b32 s40, 32768
  buffer_load_dwordx2 v[104:105], v6, s[32:35], s40 offen nt
  s_mov_b32 s40, 40960
  buffer_load_dwordx2 v[106:107], v6, s[32:35], s40 offen nt
  s_mov_b32 s40, 49152
  buffer_load_dwordx2 v[108:109], v6, s[32:35], s40 offen nt
  s_mov_b32 s40, 57344
  buffer_load_dwordx2 v[110:111], v6, s[32:35], s40 offen nt
  s_mov_b32 s40, 262144
  buffer_load_dwordx2 v[112:113], v6, s[32:35], s40 offen nt
  s_mov_b32 s40, 270336
  buffer_load_dwordx2 v[114:115], v6, s[32:35], s40 offen nt
  s_mov_b32 s40, 278528
  buffer_load_dwordx2 v[116:117], v6, s[32:35], s40 offen nt
  s_mov_b32 s40, 286720
  buffer_load_dwordx2 v[118:119], v6, s[32:35], s40 offen nt
  s_mov_b32 s40, 294912
  buffer_load_dwordx2 v[120:121], v6, s[32:35], s40 offen nt
  s_mov_b32 s40, 303104
  buffer_load_dwordx2 v[122:123], v6, s[32:35], s40 offen nt
  s_mov_b32 s40, 311296
  buffer_load_dwordx2 v[124:125], v6, s[32:35], s40 offen nt
  s_mov_b32 s40, 319488
  buffer_load_dwordx2 v[126:127], v6, s[32:35], s40 offen nt
  s_mov_b32 s40, 524288
  buffer_load_dwordx2 v[128:129], v6, s[32:35], s40 offen nt
  s_mov_b32 s40, 532480
  buffer_load_dwordx2 v[130:131], v6, s[32:35], s40 offen nt
  s_mov_b32 s40, 540672
  buffer_load_dwordx2 v[132:133], v6, s[32:35], s40 offen nt
  s_mov_b32 s40, 548864
  buffer_load_dwordx2 v[134:135], v6, s[32:35], s40 offen nt
  s_mov_b32 s40, 557056
  buffer_load_dwordx2 v[136:137], v6, s[32:35], s40 offen nt
  s_mov_b32 s40, 565248
  buffer_load_dwordx2 v[138:139], v6, s[32:35], s40 offen nt
  s_mov_b32 s40, 573440
  buffer_load_dwordx2 v[140:141], v6, s[32:35], s40 offen nt
  s_mov_b32 s40, 581632
  buffer_load_dwordx2 v[142:143], v6, s[32:35], s40 offen nt
  s_mov_b32 s40, 786432
  buffer_load_dwordx2 v[144:145], v6, s[32:35], s40 offen nt
  s_mov_b32 s40, 794624
  buffer_load_dwordx2 v[146:147], v6, s[32:35], s40 offen nt
  s_mov_b32 s40, 802816
  buffer_load_dwordx2 v[148:149], v6, s[32:35], s40 offen nt
  s_mov_b32 s40, 811008
  buffer_load_dwordx2 v[150:151], v6, s[32:35], s40 offen nt
  s_mov_b32 s40, 819200
  buffer_load_dwordx2 v[152:153], v6, s[32:35], s40 offen nt
  s_mov_b32 s40, 827392
  buffer_load_dwordx2 v[154:155], v6, s[32:35], s40 offen nt
  s_mov_b32 s40, 835584
  buffer_load_dwordx2 v[156:157], v6, s[32:35], s40 offen nt
  s_mov_b32 s40, 843776
  buffer_load_dwordx2 v[158:159], v6, s[32:35], s40 offen nt
  s_mov_b32 s40, 1048576
  buffer_load_dwordx2 v[160:161], v6, s[32:35], s40 offen nt
  s_mov_b32 s40, 1056768
  buffer_load_dwordx2 v[162:163], v6, s[32:35], s40 offen nt
  s_mov_b32 s40, 1064960
  buffer_load_dwordx2 v[164:165], v6, s[32:35], s40 offen nt
  s_mov_b32 s40, 1073152
  buffer_load_dwordx2 v[166:167], v6, s[32:35], s40 offen nt
  s_mov_b32 s40, 1081344
  buffer_load_dwordx2 v[168:169], v6, s[32:35], s40 offen nt
  s_mov_b32 s40, 1089536
  buffer_load_dwordx2 v[170:171], v6, s[32:35], s40 offen nt
  s_mov_b32 s40, 1097728
  buffer_load_dwordx2 v[172:173], v6, s[32:35], s40 offen nt
  s_mov_b32 s40, 1105920
  buffer_load_dwordx2 v[174:175], v6, s[32:35], s40 offen nt
  v_lshlrev_b32 v8, 2, v3
  v_mov_b32 v9, -1.0
  ds_write_b32 v8, v9 offset:26944
  v_mov_b32 v9, 0
  ds_write_b32 v8, v9 offset:27008
  v_lshlrev_b32 v9, 11, v2
  v_lshl_add_u32 v9, v3, 4, v9
  v_lshlrev_b32 v8, 4, v1
  s_lshl_b32 s47, s28, 13
  s_add_u32 s47, s47, 1310720
  s_lshl_b32 s45, s45, 10
  s_lshl_b32 s46, s46, 8
  s_add_u32 s46, s46, s45
  s_add_u32 s46, s46, s47
  s_lshl_b32 s45, s30, 11
  s_add_u32 s47, s47, s45
  s_mov_b32 s36, s26
  s_mov_b32 s37, s27
  s_mov_b32 s38, 2097152
  s_mov_b32 s39, 0x20000
  s_mov_b32 s56, s22
  s_mov_b32 s57, s23
  s_mov_b32 s58, 5120
  s_mov_b32 s59, 0x20000
  s_mov_b32 s98, 0x07060500
  s_mov_b32 s99, 0x07060501
  s_mov_b32 s100, 0x07060502
  s_mov_b32 s101, 0x07060503
  s_waitcnt lgkmcnt(0)
  s_add_u32 s61, s61, 0x9e3779b9
  v_mov_b32 v10, s61
  s_and_b32 s94, s61, 0xff
  s_bfe_u32 s95, s61, 0x80008
  s_bfe_u32 s96, s61, 0x80010
  s_lshr_b32 s97, s61, 24
  s_waitcnt vmcnt(40)
  v_lshlrev_b32 v48, 16, v12
  v_and_b32 v49, 0xffff0000, v12
  v_lshlrev_b32 v50, 16, v13
  v_and_b32 v51, 0xffff0000, v13
  v_lshlrev_b32 v52, 16, v14
  v_and_b32 v53, 0xffff0000, v14
  v_lshlrev_b32 v54, 16, v15
  v_and_b32 v55, 0xffff0000, v15
  v_lshlrev_b32 v56, 16, v16
  v_and_b32 v57, 0xffff0000, v16
  v_lshlrev_b32 v58, 16, v17
  v_and_b32 v59, 0xffff0000, v17
  v_lshlrev_b32 v60, 16, v18
  v_and_b32 v61, 0xffff0000, v18
  v_lshlrev_b32 v62, 16, v19
  v_and_b32 v63, 0xffff0000, v19
  v_lshlrev_b32 v64, 16, v20
  v_and_b32 v65, 0xffff0000, v20
  v_lshlrev_b32 v66, 16, v21
  v_and_b32 v67, 0xffff0000, v21
  v_lshlrev_b32 v68, 16, v22
  v_and_b32 v69, 0xffff0000, v22
  v_lshlrev_b32 v70, 16, v23
  v_and_b32 v71, 0xffff0000, v23
  v_lshlrev_b32 v72, 16, v24
  v_and_b32 v73, 0xffff0000, v24
  v_lshlrev_b32 v74, 16, v25
  v_and_b32 v75, 0xffff0000, v25
  v_lshlrev_b32 v76, 16, v26
  v_and_b32 v77, 0xffff0000, v26
  v_lshlrev_b32 v78, 16, v27
  v_and_b32 v79, 0xffff0000, v27
  v_lshlrev_b32 v80, 16, v28
  v_and_b32 v81, 0xffff0000, v28
  v_lshlrev_b32 v82, 16, v29
  v_and_b32 v83, 0xffff0000, v29
  v_lshlrev_b32 v84, 16, v30
  v_and_b32 v85, 0xffff0000, v30
  v_lshlrev_b32 v86, 16, v31
  v_and_b32 v87, 0xffff0000, v31
  v_pk_add_f32 v[88:89], v[48:49], v[50:51]
  v_pk_add_f32 v[90:91], v[52:53], v[54:55]
  v_pk_add_f32 v[88:89], v[88:89], v[56:57]
  v_pk_add_f32 v[90:91], v[90:91], v[58:59]
  v_pk_add_f32 v[88:89], v[88:89], v[60:61]
  v_pk_add_f32 v[90:91], v[90:91], v[62:63]
  v_pk_add_f32 v[88:89], v[88:89], v[64:65]
  v_pk_add_f32 v[90:91], v[90:91], v[66:67]
  v_pk_add_f32 v[88:89], v[88:89], v[68:69]
  v_pk_add_f32 v[90:91], v[90:91], v[70:71]
  v_pk_add_f32 v[88:89], v[88:89], v[72:73]
  v_pk_add_f32 v[90:91], v[90:91], v[74:75]
  v_pk_add_f32 v[88:89], v[88:89], v[76:77]
  v_pk_add_f32 v[90:91], v[90:91], v[78:79]
  v_pk_add_f32 v[88:89], v[88:89], v[80:81]
  v_pk_add_f32 v[90:91], v[90:91], v[82:83]
  v_pk_add_f32 v[88:89], v[88:89], v[84:85]
  v_pk_add_f32 v[90:91], v[90:91], v[86:87]
  v_pk_add_f32 v[88:89], v[88:89], v[90:91]
  v_add_f32 v88, v88, v89
  s_nop 1
  v_add_f32_dpp v88, v88, v88 quad_perm:[1,0,3,2] row_mask:0xf bank_mask:0xf
  s_nop 1
  v_add_f32_dpp v88, v88, v88 quad_perm:[2,3,0,1] row_mask:0xf bank_mask:0xf
  v_mov_b32 v90, v88
  s_nop 1
  v_permlane16_swap_b32 v88, v90
  v_add_f32 v88, v88, v90
  v_mov_b32 v90, v88
  s_nop 1
  v_permlane32_swap_b32 v88, v90
  v_add_f32 v88, v88, v90
  v_mul_f32 v92, 0xbacccccd, v88
  v_pk_add_f32 v[12:13], v[48:49], v[92:93] op_sel_hi:[1,0]
  v_pk_mul_f32 v[88:89], v[12:13], v[12:13]
  v_pk_add_f32 v[14:15], v[50:51], v[92:93] op_sel_hi:[1,0]
  v_pk_mul_f32 v[90:91], v[14:15], v[14:15]
  v_pk_add_f32 v[16:17], v[52:53], v[92:93] op_sel_hi:[1,0]
  v_pk_fma_f32 v[88:89], v[16:17], v[16:17], v[88:89]
  v_pk_add_f32 v[18:19], v[54:55], v[92:93] op_sel_hi:[1,0]
  v_pk_fma_f32 v[90:91], v[18:19], v[18:19], v[90:91]
  v_pk_add_f32 v[20:21], v[56:57], v[92:93] op_sel_hi:[1,0]
  v_pk_fma_f32 v[88:89], v[20:21], v[20:21], v[88:89]
  v_pk_add_f32 v[22:23], v[58:59], v[92:93] op_sel_hi:[1,0]
  v_pk_fma_f32 v[90:91], v[22:23], v[22:23], v[90:91]
  v_pk_add_f32 v[24:25], v[60:61], v[92:93] op_sel_hi:[1,0]
  v_pk_fma_f32 v[88:89], v[24:25], v[24:25], v[88:89]
  v_pk_add_f32 v[26:27], v[62:63], v[92:93] op_sel_hi:[1,0]
  v_pk_fma_f32 v[90:91], v[26:27], v[26:27], v[90:91]
  v_pk_add_f32 v[28:29], v[64:65], v[92:93] op_sel_hi:[1,0]
  v_pk_fma_f32 v[88:89], v[28:29], v[28:29], v[88:89]
  v_pk_add_f32 v[30:31], v[66:67], v[92:93] op_sel_hi:[1,0]
  v_pk_fma_f32 v[90:91], v[30:31], v[30:31], v[90:91]
  v_pk_add_f32 v[12:13], v[68:69], v[92:93] op_sel_hi:[1,0]
  v_pk_fma_f32 v[88:89], v[12:13], v[12:13], v[88:89]
  v_pk_add_f32 v[14:15], v[70:71], v[92:93] op_sel_hi:[1,0]
  v_pk_fma_f32 v[90:91], v[14:15], v[14:15], v[90:91]
  v_pk_add_f32 v[16:17], v[72:73], v[92:93] op_sel_hi:[1,0]
  v_pk_fma_f32 v[88:89], v[16:17], v[16:17], v[88:89]
  v_pk_add_f32 v[18:19], v[74:75], v[92:93] op_sel_hi:[1,0]
  v_pk_fma_f32 v[90:91], v[18:19], v[18:19], v[90:91]
  v_pk_add_f32 v[20:21], v[76:77], v[92:93] op_sel_hi:[1,0]
  v_pk_fma_f32 v[88:89], v[20:21], v[20:21], v[88:89]
  v_pk_add_f32 v[22:23], v[78:79], v[92:93] op_sel_hi:[1,0]
  v_pk_fma_f32 v[90:91], v[22:23], v[22:23], v[90:91]
  v_pk_add_f32 v[24:25], v[80:81], v[92:93] op_sel_hi:[1,0]
  v_pk_fma_f32 v[88:89], v[24:25], v[24:25], v[88:89]
  v_pk_add_f32 v[26:27], v[82:83], v[92:93] op_sel_hi:[1,0]
  v_pk_fma_f32 v[90:91], v[26:27], v[26:27], v[90:91]
  v_pk_add_f32 v[28:29], v[84:85], v[92:93] op_sel_hi:[1,0]
  v_pk_fma_f32 v[88:89], v[28:29], v[28:29], v[88:89]
  v_pk_add_f32 v[30:31], v[86:87], v[92:93] op_sel_hi:[1,0]
  v_pk_fma_f32 v[90:91], v[30:31], v[30:31], v[90:91]
  v_pk_add_f32 v[88:89], v[88:89], v[90:91]
  v_add_f32 v88, v88, v89
  s_nop 1
  v_add_f32_dpp v88, v88, v88 quad_perm:[1,0,3,2] row_mask:0xf bank_mask:0xf
  s_nop 1
  v_add_f32_dpp v88, v88, v88 quad_perm:[2,3,0,1] row_mask:0xf bank_mask:0xf
  v_mov_b32 v90, v88
  s_nop 1
  v_permlane16_swap_b32 v88, v90
  v_add_f32 v88, v88, v90
  v_mov_b32 v90, v88
  s_nop 1
  v_permlane32_swap_b32 v88, v90
  v_add_f32 v88, v88, v90
  v_mul_f32 v94, 0x3acccccd, v88
  v_cvt_pk_bf16_f32 v92, v92, v92
  v_and_b32 v92, 0xffff0000, v92
  v_cvt_pk_bf16_f32 v94, v94, v94
  v_and_b32 v94, 0xffff0000, v94
  v_add_f32 v94, 0x3727c5ac, v94
  v_cvt_pk_bf16_f32 v94, v94, v94
  v_and_b32 v94, 0xffff0000, v94
  v_sqrt_f32 v94, v94
  s_nop 0
  v_cvt_pk_bf16_f32 v94, v94, v94
  v_and_b32 v94, 0xffff0000, v94
  v_rcp_f32 v94, v94
  v_pk_add_f32 v[48:49], v[48:49], v[92:93] op_sel_hi:[1,0]
  v_pk_add_f32 v[50:51], v[50:51], v[92:93] op_sel_hi:[1,0]
  v_pk_add_f32 v[52:53], v[52:53], v[92:93] op_sel_hi:[1,0]
  v_pk_add_f32 v[54:55], v[54:55], v[92:93] op_sel_hi:[1,0]
  v_pk_add_f32 v[56:57], v[56:57], v[92:93] op_sel_hi:[1,0]
  v_pk_add_f32 v[58:59], v[58:59], v[92:93] op_sel_hi:[1,0]
  v_pk_add_f32 v[60:61], v[60:61], v[92:93] op_sel_hi:[1,0]
  v_pk_add_f32 v[62:63], v[62:63], v[92:93] op_sel_hi:[1,0]
  v_pk_add_f32 v[64:65], v[64:65], v[92:93] op_sel_hi:[1,0]
  v_pk_add_f32 v[66:67], v[66:67], v[92:93] op_sel_hi:[1,0]
  v_pk_add_f32 v[68:69], v[68:69], v[92:93] op_sel_hi:[1,0]
  v_pk_add_f32 v[70:71], v[70:71], v[92:93] op_sel_hi:[1,0]
  v_pk_add_f32 v[72:73], v[72:73], v[92:93] op_sel_hi:[1,0]
  v_pk_add_f32 v[74:75], v[74:75], v[92:93] op_sel_hi:[1,0]
  v_pk_add_f32 v[76:77], v[76:77], v[92:93] op_sel_hi:[1,0]
  v_pk_add_f32 v[78:79], v[78:79], v[92:93] op_sel_hi:[1,0]
  v_pk_add_f32 v[80:81], v[80:81], v[92:93] op_sel_hi:[1,0]
  v_pk_add_f32 v[82:83], v[82:83], v[92:93] op_sel_hi:[1,0]
  v_pk_add_f32 v[84:85], v[84:85], v[92:93] op_sel_hi:[1,0]
  v_pk_add_f32 v[86:87], v[86:87], v[92:93] op_sel_hi:[1,0]
  v_cvt_pk_bf16_f32 v12, v48, v49
  v_cvt_pk_bf16_f32 v13, v50, v51
  v_cvt_pk_bf16_f32 v14, v52, v53
  v_cvt_pk_bf16_f32 v15, v54, v55
  v_cvt_pk_bf16_f32 v16, v56, v57
  v_cvt_pk_bf16_f32 v17, v58, v59
  v_cvt_pk_bf16_f32 v18, v60, v61
  v_cvt_pk_bf16_f32 v19, v62, v63
  v_cvt_pk_bf16_f32 v20, v64, v65
  v_cvt_pk_bf16_f32 v21, v66, v67
  v_cvt_pk_bf16_f32 v22, v68, v69
  v_cvt_pk_bf16_f32 v23, v70, v71
  v_cvt_pk_bf16_f32 v24, v72, v73
  v_cvt_pk_bf16_f32 v25, v74, v75
  v_cvt_pk_bf16_f32 v26, v76, v77
  v_cvt_pk_bf16_f32 v27, v78, v79
  v_cvt_pk_bf16_f32 v28, v80, v81
  v_cvt_pk_bf16_f32 v29, v82, v83
  v_cvt_pk_bf16_f32 v30, v84, v85
  v_cvt_pk_bf16_f32 v31, v86, v87
  v_lshlrev_b32 v48, 16, v12
  v_and_b32 v49, 0xffff0000, v12
  v_lshlrev_b32 v50, 16, v13
  v_and_b32 v51, 0xffff0000, v13
  v_lshlrev_b32 v52, 16, v14
  v_and_b32 v53, 0xffff0000, v14
  v_lshlrev_b32 v54, 16, v15
  v_and_b32 v55, 0xffff0000, v15
  v_lshlrev_b32 v56, 16, v16
  v_and_b32 v57, 0xffff0000, v16
  v_lshlrev_b32 v58, 16, v17
  v_and_b32 v59, 0xffff0000, v17
  v_lshlrev_b32 v60, 16, v18
  v_and_b32 v61, 0xffff0000, v18
  v_lshlrev_b32 v62, 16, v19
  v_and_b32 v63, 0xffff0000, v19
  v_lshlrev_b32 v64, 16, v20
  v_and_b32 v65, 0xffff0000, v20
  v_lshlrev_b32 v66, 16, v21
  v_and_b32 v67, 0xffff0000, v21
  v_lshlrev_b32 v68, 16, v22
  v_and_b32 v69, 0xffff0000, v22
  v_lshlrev_b32 v70, 16, v23
  v_and_b32 v71, 0xffff0000, v23
  v_lshlrev_b32 v72, 16, v24
  v_and_b32 v73, 0xffff0000, v24
  v_lshlrev_b32 v74, 16, v25
  v_and_b32 v75, 0xffff0000, v25
  v_lshlrev_b32 v76, 16, v26
  v_and_b32 v77, 0xffff0000, v26
  v_lshlrev_b32 v78, 16, v27
  v_and_b32 v79, 0xffff0000, v27
  v_lshlrev_b32 v80, 16, v28
  v_and_b32 v81, 0xffff0000, v28
  v_lshlrev_b32 v82, 16, v29
  v_and_b32 v83, 0xffff0000, v29
  v_lshlrev_b32 v84, 16, v30
  v_and_b32 v85, 0xffff0000, v30
  v_lshlrev_b32 v86, 16, v31
  v_and_b32 v87, 0xffff0000, v31
  v_pk_mul_f32 v[48:49], v[48:49], v[94:95] op_sel_hi:[1,0]
  v_pk_mul_f32 v[50:51], v[50:51], v[94:95] op_sel_hi:[1,0]
  v_pk_mul_f32 v[52:53], v[52:53], v[94:95] op_sel_hi:[1,0]
  v_pk_mul_f32 v[54:55], v[54:55], v[94:95] op_sel_hi:[1,0]
  v_pk_mul_f32 v[56:57], v[56:57], v[94:95] op_sel_hi:[1,0]
  v_pk_mul_f32 v[58:59], v[58:59], v[94:95] op_sel_hi:[1,0]
  v_pk_mul_f32 v[60:61], v[60:61], v[94:95] op_sel_hi:[1,0]
  v_pk_mul_f32 v[62:63], v[62:63], v[94:95] op_sel_hi:[1,0]
  v_pk_mul_f32 v[64:65], v[64:65], v[94:95] op_sel_hi:[1,0]
  v_pk_mul_f32 v[66:67], v[66:67], v[94:95] op_sel_hi:[1,0]
  v_pk_mul_f32 v[68:69], v[68:69], v[94:95] op_sel_hi:[1,0]
  v_pk_mul_f32 v[70:71], v[70:71], v[94:95] op_sel_hi:[1,0]
  v_pk_mul_f32 v[72:73], v[72:73], v[94:95] op_sel_hi:[1,0]
  v_pk_mul_f32 v[74:75], v[74:75], v[94:95] op_sel_hi:[1,0]
  v_pk_mul_f32 v[76:77], v[76:77], v[94:95] op_sel_hi:[1,0]
  v_pk_mul_f32 v[78:79], v[78:79], v[94:95] op_sel_hi:[1,0]
  v_pk_mul_f32 v[80:81], v[80:81], v[94:95] op_sel_hi:[1,0]
  v_pk_mul_f32 v[82:83], v[82:83], v[94:95] op_sel_hi:[1,0]
  v_pk_mul_f32 v[84:85], v[84:85], v[94:95] op_sel_hi:[1,0]
  v_pk_mul_f32 v[86:87], v[86:87], v[94:95] op_sel_hi:[1,0]
  v_cvt_pk_bf16_f32 v12, v48, v49
  v_cvt_pk_bf16_f32 v13, v50, v51
  v_cvt_pk_bf16_f32 v14, v52, v53
  v_cvt_pk_bf16_f32 v15, v54, v55
  v_cvt_pk_bf16_f32 v16, v56, v57
  v_cvt_pk_bf16_f32 v17, v58, v59
  v_cvt_pk_bf16_f32 v18, v60, v61
  v_cvt_pk_bf16_f32 v19, v62, v63
  v_cvt_pk_bf16_f32 v20, v64, v65
  v_cvt_pk_bf16_f32 v21, v66, v67
  v_cvt_pk_bf16_f32 v22, v68, v69
  v_cvt_pk_bf16_f32 v23, v70, v71
  v_cvt_pk_bf16_f32 v24, v72, v73
  v_cvt_pk_bf16_f32 v25, v74, v75
  v_cvt_pk_bf16_f32 v26, v76, v77
  v_cvt_pk_bf16_f32 v27, v78, v79
  v_cvt_pk_bf16_f32 v28, v80, v81
  v_cvt_pk_bf16_f32 v29, v82, v83
  v_cvt_pk_bf16_f32 v30, v84, v85
  v_cvt_pk_bf16_f32 v31, v86, v87
  s_waitcnt vmcnt(32)
  v_perm_b32 v176, v98, v96, s41
  v_perm_b32 v177, v102, v100, s41
  v_perm_b32 v178, v106, v104, s41
  v_perm_b32 v179, v110, v108, s41
  v_perm_b32 v180, v98, v96, s42
  v_perm_b32 v181, v102, v100, s42
  v_perm_b32 v182, v106, v104, s42
  v_perm_b32 v183, v110, v108, s42
  v_perm_b32 v184, v99, v97, s41
  v_perm_b32 v185, v103, v101, s41
  v_perm_b32 v186, v107, v105, s41
  v_perm_b32 v187, v111, v109, s41
  v_perm_b32 v188, v99, v97, s42
  v_perm_b32 v189, v103, v101, s42
  v_perm_b32 v190, v107, v105, s42
  v_perm_b32 v191, v111, v109, s42
  s_waitcnt vmcnt(24)
  v_perm_b32 v192, v114, v112, s41
  v_perm_b32 v193, v118, v116, s41
  v_perm_b32 v194, v122, v120, s41
  v_perm_b32 v195, v126, v124, s41
  v_mfma_f32_16x16x32_bf16 v[32:35], v[12:15], v[176:179], 0
  v_perm_b32 v196, v114, v112, s42
  v_perm_b32 v197, v118, v116, s42
  v_perm_b32 v198, v122, v120, s42
  v_perm_b32 v199, v126, v124, s42
  v_mfma_f32_16x16x32_bf16 v[36:39], v[12:15], v[180:183], 0
  v_perm_b32 v200, v115, v113, s41
  v_perm_b32 v201, v119, v117, s41
  v_perm_b32 v202, v123, v121, s41
  v_perm_b32 v203, v127, v125, s41
  v_mfma_f32_16x16x32_bf16 v[40:43], v[12:15], v[184:187], 0
  v_perm_b32 v204, v115, v113, s42
  v_perm_b32 v205, v119, v117, s42
  v_perm_b32 v206, v123, v121, s42
  v_perm_b32 v207, v127, v125, s42
  v_mfma_f32_16x16x32_bf16 v[44:47], v[12:15], v[188:191], 0
  s_waitcnt vmcnt(16)
  v_perm_b32 v208, v130, v128, s41
  v_perm_b32 v209, v134, v132, s41
  v_perm_b32 v210, v138, v136, s41
  v_perm_b32 v211, v142, v140, s41
  v_mfma_f32_16x16x32_bf16 v[32:35], v[16:19], v[192:195], v[32:35]
  v_perm_b32 v212, v130, v128, s42
  v_perm_b32 v213, v134, v132, s42
  v_perm_b32 v214, v138, v136, s42
  v_perm_b32 v215, v142, v140, s42
  v_mfma_f32_16x16x32_bf16 v[36:39], v[16:19], v[196:199], v[36:39]
  v_perm_b32 v216, v131, v129, s41
  v_perm_b32 v217, v135, v133, s41
  v_perm_b32 v218, v139, v137, s41
  v_perm_b32 v219, v143, v141, s41
  v_mfma_f32_16x16x32_bf16 v[40:43], v[16:19], v[200:203], v[40:43]
  v_perm_b32 v220, v131, v129, s42
  v_perm_b32 v221, v135, v133, s42
  v_perm_b32 v222, v139, v137, s42
  v_perm_b32 v223, v143, v141, s42
  v_mfma_f32_16x16x32_bf16 v[44:47], v[16:19], v[204:207], v[44:47]
  s_waitcnt vmcnt(8)
  v_perm_b32 v224, v146, v144, s41
  v_perm_b32 v225, v150, v148, s41
  v_perm_b32 v226, v154, v152, s41
  v_perm_b32 v227, v158, v156, s41
  v_mfma_f32_16x16x32_bf16 v[32:35], v[20:23], v[208:211], v[32:35]
  v_perm_b32 v228, v146, v144, s42
  v_perm_b32 v229, v150, v148, s42
  v_perm_b32 v230, v154, v152, s42
  v_perm_b32 v231, v158, v156, s42
  v_mfma_f32_16x16x32_bf16 v[36:39], v[20:23], v[212:215], v[36:39]
  v_perm_b32 v232, v147, v145, s41
  v_perm_b32 v233, v151, v149, s41
  v_perm_b32 v234, v155, v153, s41
  v_perm_b32 v235, v159, v157, s41
  v_mfma_f32_16x16x32_bf16 v[40:43], v[20:23], v[216:219], v[40:43]
  v_perm_b32 v236, v147, v145, s42
  v_perm_b32 v237, v151, v149, s42
  v_perm_b32 v238, v155, v153, s42
  v_perm_b32 v239, v159, v157, s42
  v_mfma_f32_16x16x32_bf16 v[44:47], v[20:23], v[220:223], v[44:47]
  s_waitcnt vmcnt(0)
  v_perm_b32 v240, v162, v160, s41
  v_perm_b32 v241, v166, v164, s41
  v_perm_b32 v242, v170, v168, s41
  v_perm_b32 v243, v174, v172, s41
  v_mfma_f32_16x16x32_bf16 v[32:35], v[24:27], v[224:227], v[32:35]
  v_perm_b32 v244, v162, v160, s42
  v_perm_b32 v245, v166, v164, s42
  v_perm_b32 v246, v170, v168, s42
  v_perm_b32 v247, v174, v172, s42
  v_mfma_f32_16x16x32_bf16 v[36:39], v[24:27], v[228:231], v[36:39]
  v_perm_b32 v248, v163, v161, s41
  v_perm_b32 v249, v167, v165, s41
  v_perm_b32 v250, v171, v169, s41
  v_perm_b32 v251, v175, v173, s41
  v_mfma_f32_16x16x32_bf16 v[40:43], v[24:27], v[232:235], v[40:43]
  v_perm_b32 v252, v163, v161, s42
  v_perm_b32 v253, v167, v165, s42
  v_perm_b32 v254, v171, v169, s42
  v_perm_b32 v255, v175, v173, s42
  v_mfma_f32_16x16x32_bf16 v[44:47], v[24:27], v[236:239], v[44:47]
  v_mfma_f32_16x16x32_bf16 v[32:35], v[28:31], v[240:243], v[32:35]
  v_mfma_f32_16x16x32_bf16 v[36:39], v[28:31], v[244:247], v[36:39]
  v_mfma_f32_16x16x32_bf16 v[40:43], v[28:31], v[248:251], v[40:43]
  v_mfma_f32_16x16x32_bf16 v[44:47], v[28:31], v[252:255], v[44:47]
  s_nop 4
  v_add_u32 v64, 0x80, v32
  v_add_u32 v65, 0x80, v36
  v_add_u32 v66, 0x80, v40
  v_add_u32 v67, 0x80, v44
  v_perm_b32 v64, v64, v10, s98
  v_perm_b32 v65, v65, v10, s99
  v_perm_b32 v66, v66, v10, s100
  v_perm_b32 v67, v67, v10, s101
  buffer_store_dwordx4 v[64:67], v9, s[36:39], s46 offen sc1
  v_lshrrev_b32 v11, 1, v2
  v_lshlrev_b32 v11, 7, v11
  v_lshl_add_u32 v11, v3, 3, v11
  v_and_b32 v6, 1, v2
  v_lshl_add_u32 v11, v6, 2, v11
  s_mul_i32 s34, s28, 163840
  s_mul_i32 s45, s3, 320
  s_add_u32 s34, s34, s45
  s_add_u32 s32, s12, s34
  s_addc_u32 s33, s13, 0
  s_sub_u32 s34, 163840, s45
  s_mov_b32 s35, 0x20000
  v_mul_u32_u24 v6, 10240, v2
  v_lshl_add_u32 v7, v3, 2, v6
  v_lshl_add_u32 v6, v3, 4, v6
  s_mov_b32 s40, 0
  buffer_load_dwordx4 v[96:99], v6, s[32:35], s40 offen
  buffer_load_dword v224, v7, s[32:35], s40 offen offset:256
  s_mov_b32 s40, 1280
  s_waitcnt vmcnt(0)
  buffer_load_dwordx4 v[100:103], v6, s[32:35], s40 offen
  buffer_load_dword v225, v7, s[32:35], s40 offen offset:256
  s_mov_b32 s40, 2560
  s_waitcnt vmcnt(0)
  buffer_load_dwordx4 v[104:107], v6, s[32:35], s40 offen
  buffer_load_dword v226, v7, s[32:35], s40 offen offset:256
  s_mov_b32 s90, 0
L_pu1:
  buffer_load_dwordx4 v[32:35], v8, s[36:39], s47 offen offset:0 sc1
  buffer_load_dwordx4 v[36:39], v8, s[36:39], s47 offen offset:1024 sc1
  s_waitcnt vmcnt(0)
  v_xor_b32 v32, s94, v32
  v_xor_b32 v33, s95, v33
  v_xor_b32 v34, s96, v34
  v_xor_b32 v35, s97, v35
  v_xor_b32 v36, s94, v36
  v_xor_b32 v37, s95, v37
  v_xor_b32 v38, s96, v38
  v_xor_b32 v39, s97, v39
  v_or_b32 v40, v32, v33
  v_or3_b32 v40, v40, v34, v35
  v_or3_b32 v40, v40, v36, v37
  v_or3_b32 v40, v40, v38, v39
  v_and_b32 v40, 0xff, v40
  v_cmp_ne_u32 vcc, 0, v40
  s_nop 0
  s_cmp_eq_u64 vcc, 0
  s_nop 1
  s_cbranch_scc1 L_pu1_ok
  s_mov_b64 exec, vcc
  s_sleep 16
  s_add_u32 s90, s90, 1
  s_cmp_lt_u32 s90, 65536
  s_cbranch_scc1 L_pu1
L_pu1_ok:
  s_mov_b64 exec, -1
  v_permlane32_swap_b32 v32, v36
  v_permlane32_swap_b32 v33, v37
  v_permlane32_swap_b32 v34, v38
  v_permlane32_swap_b32 v35, v39
  v_add_f32 v32, v32, v36
  v_add_f32 v33, v33, v37
  v_add_f32 v34, v34, v38
  v_add_f32 v35, v35, v39
  s_nop 0
  v_permlane16_swap_b32 v32, v34
  v_permlane16_swap_b32 v33, v35
  v_add_f32 v32, v32, v34
  v_add_f32 v33, v33, v35
  v_cvt_pk_bf16_f32 v32, v32, v33
  ds_write_b32 v11, v32 offset:21504
  s_waitcnt lgkmcnt(0)
  s_branch L_bar1
L_side:
  s_waitcnt lgkmcnt(0)
  s_mov_b32 s48, s4
  s_mov_b32 s49, s5
  s_load_dword s61, s[26:27], 0
  s_cmp_ge_u32 s31, 21
  s_cbranch_scc1 L_pf
  s_cmp_lg_u32 s3, 1
  s_cbranch_scc1 L_idle
  s_cmp_ge_u32 s31, 14
  s_cbranch_scc1 L_s2a
  s_mul_i32 s45, s89, 14
  s_add_u32 s45, s45, s31
  s_and_b32 s46, s45, 3
  v_lshrrev_b32 v4, 2, v3
  v_mul_u32_u24 v4, 1280, v4
  v_lshl_add_u32 v4, v2, 4, v4
  v_and_b32 v5, 3, v3
  v_xor_b32 v5, s46, v5
  v_mul_u32_u24 v5, 320, v5
  v_add_u32 v4, v4, v5
  buffer_load_dwordx4 v[12:15], v4, s[48:51], 0 offen offset:0
  buffer_load_dwordx4 v[16:19], v4, s[48:51], 0 offen offset:64
  buffer_load_dwordx4 v[20:23], v4, s[48:51], 0 offen offset:128
  buffer_load_dwordx4 v[24:27], v4, s[48:51], 0 offen offset:192
  buffer_load_dwordx4 v[28:31], v4, s[48:51], 0 offen offset:256
  s_lshr_b32 s62, s45, 2
  s_cmp_ge_u32 s62, 14
  s_cselect_b32 s32, s18, s16
  s_cselect_b32 s33, s19, s17
  s_cselect_b32 s47, 14, 0
  s_cselect_b32 s60, 4, 0
  s_sub_u32 s62, s62, s47
  s_add_u32 s60, s60, s46
  s_lshl_b32 s47, s62, 3
  s_add_u32 s60, s60, s47
  s_lshl_b32 s60, s60, 11
  s_add_u32 s60, s60, 1048576
  s_mul_i32 s47, s46, 552960
  s_lshl_b32 s45, s62, 8
  s_add_u32 s47, s47, s45
  s_add_u32 s32, s32, s47
  s_addc_u32 s33, s33, 0
  s_sub_u32 s34, 2211840, s47
  v_mul_u32_u24 v6, 27648, v2
  v_lshl_add_u32 v6, v3, 4, v6
  s_cmp_eq_u32 s62, 13
  s_cselect_b32 s45, 8, 16
  v_mov_b32 v7, 2147483648
  v_cmp_gt_u32 vcc, s45, v3
  s_nop 1
  v_cndmask_b32 v6, v7, v6, vcc
  s_mov_b32 s40, 0
  buffer_load_dwordx4 v[96:99], v6, s[32:35], s40 offen nt
  s_mov_b32 s40, 3456
  buffer_load_dwordx4 v[100:103], v6, s[32:35], s40 offen nt
  s_mov_b32 s40, 6912
  buffer_load_dwordx4 v[104:107], v6, s[32:35], s40 offen nt
  s_mov_b32 s40, 10368
  buffer_load_dwordx4 v[108:111], v6, s[32:35], s40 offen nt
  s_mov_b32 s40, 13824
  buffer_load_dwordx4 v[112:115], v6, s[32:35], s40 offen nt
  s_mov_b32 s40, 17280
  buffer_load_dwordx4 v[116:119], v6, s[32:35], s40 offen nt
  s_mov_b32 s40, 20736
  buffer_load_dwordx4 v[120:123], v6, s[32:35], s40 offen nt
  s_mov_b32 s40, 24192
  buffer_load_dwordx4 v[124:127], v6, s[32:35], s40 offen nt
  s_mov_b32 s40, 110592
  buffer_load_dwordx4 v[128:131], v6, s[32:35], s40 offen nt
  s_mov_b32 s40, 114048
  buffer_load_dwordx4 v[132:135], v6, s[32:35], s40 offen nt
  s_mov_b32 s40, 117504
  buffer_load_dwordx4 v[136:139], v6, s[32:35], s40 offen nt
  s_mov_b32 s40, 120960
  buffer_load_dwordx4 v[140:143], v6, s[32:35], s40 offen nt
  s_mov_b32 s40, 124416
  buffer_load_dwordx4 v[144:147], v6, s[32:35], s40 offen nt
  s_mov_b32 s40, 127872
  buffer_load_dwordx4 v[148:151], v6, s[32:35], s40 offen nt
  s_mov_b32 s40, 131328
  buffer_load_dwordx4 v[152:155], v6, s[32:35], s40 offen nt
  s_mov_b32 s40, 134784
  buffer_load_dwordx4 v[156:159], v6, s[32:35], s40 offen nt
  s_mov_b32 s40, 221184
  buffer_load_dwordx4 v[160:163], v6, s[32:35], s40 offen nt
  s_mov_b32 s40, 224640
  buffer_load_dwordx4 v[164:167], v6, s[32:35], s40 offen nt
  s_mov_b32 s40, 228096
  buffer_load_dwordx4 v[168:171], v6, s[32:35], s40 offen nt
  s_mov_b32 s40, 231552
  buffer_load_dwordx4 v[172:175], v6, s[32:35], s40 offen nt
  s_mov_b32 s40, 235008
  buffer_load_dwordx4 v[176:179], v6, s[32:35], s40 offen nt
  s_mov_b32 s40, 238464
  buffer_load_dwordx4 v[180:183], v6, s[32:35], s40 offen nt
  s_mov_b32 s40, 241920
  buffer_load_dwordx4 v[184:187], v6, s[32:35], s40 offen nt
  s_mov_b32 s40, 245376
  buffer_load_dwordx4 v[188:191], v6, s[32:35], s40 offen nt
  s_mov_b32 s40, 331776
  buffer_load_dwordx4 v[192:195], v6, s[32:35], s40 offen nt
  s_mov_b32 s40, 335232
  buffer_load_dwordx4 v[196:199], v6, s[32:35], s40 offen nt
  s_mov_b32 s40, 338688
  buffer_load_dwordx4 v[200:203], v6, s[32:35], s40 offen nt
  s_mov_b32 s40, 342144
  buffer_load_dwordx4 v[204:207], v6, s[32:35], s40 offen nt
  s_mov_b32 s40, 345600
  buffer_load_dwordx4 v[208:211], v6, s[32:35], s40 offen nt
  s_mov_b32 s40, 349056
  buffer_load_dwordx4 v[212:215], v6, s[32:35], s40 offen nt
  s_mov_b32 s40, 352512
  buffer_load_dwordx4 v[216:219], v6, s[32:35], s40 offen nt
  s_mov_b32 s40, 355968
  buffer_load_dwordx4 v[220:223], v6, s[32:35], s40 offen nt
  s_mov_b32 s40, 442368
  buffer_load_dwordx4 v[224:227], v6, s[32:35], s40 offen nt
  s_mov_b32 s40, 445824
  buffer_load_dwordx4 v[228:231], v6, s[32:35], s40 offen nt
  s_mov_b32 s40, 449280
  buffer_load_dwordx4 v[232:235], v6, s[32:35], s40 offen nt
  s_mov_b32 s40, 452736
  buffer_load_dwordx4 v[236:239], v6, s[32:35], s40 offen nt
  s_mov_b32 s40, 456192
  buffer_load_dwordx4 v[240:243], v6, s[32:35], s40 offen nt
  s_mov_b32 s40, 459648
  buffer_load_dwordx4 v[244:247], v6, s[32:35], s40 offen nt
  s_mov_b32 s40, 463104
  buffer_load_dwordx4 v[248:251], v6, s[32:35], s40 offen nt
  s_mov_b32 s40, 466560
  buffer_load_dwordx4 v[252:255], v6, s[32:35], s40 offen nt
  s_mov_b32 s36, s26
  s_mov_b32 s37, s27
  s_mov_b32 s38, 2097152
  s_mov_b32 s39, 0x20000
  s_mov_b32 s56, s22
  s_mov_b32 s57, s23
  s_mov_b32 s58, 5120
  s_mov_b32 s59, 0x20000
  s_mov_b32 s98, 0x07060500
  s_mov_b32 s99, 0x07060501
  s_mov_b32 s100, 0x07060502
  s_mov_b32 s101, 0x07060503
  s_waitcnt lgkmcnt(0)
  s_add_u32 s61, s61, 0x9e3779b9
  v_mov_b32 v10, s61
  s_and_b32 s94, s61, 0xff
  s_bfe_u32 s95, s61, 0x80008
  s_bfe_u32 s96, s61, 0x80010
  s_lshr_b32 s97, s61, 24
  s_waitcnt vmcnt(40)
  v_lshlrev_b32 v48, 16, v12
  v_and_b32 v49, 0xffff0000, v12
  v_lshlrev_b32 v50, 16, v13
  v_and_b32 v51, 0xffff0000, v13
  v_lshlrev_b32 v52, 16, v14
  v_and_b32 v53, 0xffff0000, v14
  v_lshlrev_b32 v54, 16, v15
  v_and_b32 v55, 0xffff0000, v15
  v_lshlrev_b32 v56, 16, v16
  v_and_b32 v57, 0xffff0000, v16
  v_lshlrev_b32 v58, 16, v17
  v_and_b32 v59, 0xffff0000, v17
  v_lshlrev_b32 v60, 16, v18
  v_and_b32 v61, 0xffff0000, v18
  v_lshlrev_b32 v62, 16, v19
  v_and_b32 v63, 0xffff0000, v19
  v_lshlrev_b32 v64, 16, v20
  v_and_b32 v65, 0xffff0000, v20
  v_lshlrev_b32 v66, 16, v21
  v_and_b32 v67, 0xffff0000, v21
  v_lshlrev_b32 v68, 16, v22
  v_and_b32 v69, 0xffff0000, v22
  v_lshlrev_b32 v70, 16, v23
  v_and_b32 v71, 0xffff0000, v23
  v_lshlrev_b32 v72, 16, v24
  v_and_b32 v73, 0xffff0000, v24
  v_lshlrev_b32 v74, 16, v25
  v_and_b32 v75, 0xffff0000, v25
  v_lshlrev_b32 v76, 16, v26
  v_and_b32 v77, 0xffff0000, v26
  v_lshlrev_b32 v78, 16, v27
  v_and_b32 v79, 0xffff0000, v27
  v_lshlrev_b32 v80, 16, v28
  v_and_b32 v81, 0xffff0000, v28
  v_lshlrev_b32 v82, 16, v29
  v_and_b32 v83, 0xffff0000, v29
  v_lshlrev_b32 v84, 16, v30
  v_and_b32 v85, 0xffff0000, v30
  v_lshlrev_b32 v86, 16, v31
  v_and_b32 v87, 0xffff0000, v31
  v_pk_add_f32 v[88:89], v[48:49], v[50:51]
  v_pk_add_f32 v[90:91], v[52:53], v[54:55]
  v_pk_add_f32 v[88:89], v[88:89], v[56:57]
  v_pk_add_f32 v[90:91], v[90:91], v[58:59]
  v_pk_add_f32 v[88:89], v[88:89], v[60:61]
  v_pk_add_f32 v[90:91], v[90:91], v[62:63]
  v_pk_add_f32 v[88:89], v[88:89], v[64:65]
  v_pk_add_f32 v[90:91], v[90:91], v[66:67]
  v_pk_add_f32 v[88:89], v[88:89], v[68:69]
  v_pk_add_f32 v[90:91], v[90:91], v[70:71]
  v_pk_add_f32 v[88:89], v[88:89], v[72:73]
  v_pk_add_f32 v[90:91], v[90:91], v[74:75]
  v_pk_add_f32 v[88:89], v[88:89], v[76:77]
  v_pk_add_f32 v[90:91], v[90:91], v[78:79]
  v_pk_add_f32 v[88:89], v[88:89], v[80:81]
  v_pk_add_f32 v[90:91], v[90:91], v[82:83]
  v_pk_add_f32 v[88:89], v[88:89], v[84:85]
  v_pk_add_f32 v[90:91], v[90:91], v[86:87]
  v_pk_add_f32 v[88:89], v[88:89], v[90:91]
  v_add_f32 v88, v88, v89
  s_nop 1
  v_add_f32_dpp v88, v88, v88 quad_perm:[1,0,3,2] row_mask:0xf bank_mask:0xf
  s_nop 1
  v_add_f32_dpp v88, v88, v88 quad_perm:[2,3,0,1] row_mask:0xf bank_mask:0xf
  v_mov_b32 v90, v88
  s_nop 1
  v_permlane16_swap_b32 v88, v90
  v_add_f32 v88, v88, v90
  v_mov_b32 v90, v88
  s_nop 1
  v_permlane32_swap_b32 v88, v90
  v_add_f32 v88, v88, v90
  v_mul_f32 v92, 0xbacccccd, v88
  v_pk_add_f32 v[12:13], v[48:49], v[92:93] op_sel_hi:[1,0]
  v_pk_mul_f32 v[88:89], v[12:13], v[12:13]
  v_pk_add_f32 v[14:15], v[50:51], v[92:93] op_sel_hi:[1,0]
  v_pk_mul_f32 v[90:91], v[14:15], v[14:15]
  v_pk_add_f32 v[16:17], v[52:53], v[92:93] op_sel_hi:[1,0]
  v_pk_fma_f32 v[88:89], v[16:17], v[16:17], v[88:89]
  v_pk_add_f32 v[18:19], v[54:55], v[92:93] op_sel_hi:[1,0]
  v_pk_fma_f32 v[90:91], v[18:19], v[18:19], v[90:91]
  v_pk_add_f32 v[20:21], v[56:57], v[92:93] op_sel_hi:[1,0]
  v_pk_fma_f32 v[88:89], v[20:21], v[20:21], v[88:89]
  v_pk_add_f32 v[22:23], v[58:59], v[92:93] op_sel_hi:[1,0]
  v_pk_fma_f32 v[90:91], v[22:23], v[22:23], v[90:91]
  v_pk_add_f32 v[24:25], v[60:61], v[92:93] op_sel_hi:[1,0]
  v_pk_fma_f32 v[88:89], v[24:25], v[24:25], v[88:89]
  v_pk_add_f32 v[26:27], v[62:63], v[92:93] op_sel_hi:[1,0]
  v_pk_fma_f32 v[90:91], v[26:27], v[26:27], v[90:91]
  v_pk_add_f32 v[28:29], v[64:65], v[92:93] op_sel_hi:[1,0]
  v_pk_fma_f32 v[88:89], v[28:29], v[28:29], v[88:89]
  v_pk_add_f32 v[30:31], v[66:67], v[92:93] op_sel_hi:[1,0]
  v_pk_fma_f32 v[90:91], v[30:31], v[30:31], v[90:91]
  v_pk_add_f32 v[12:13], v[68:69], v[92:93] op_sel_hi:[1,0]
  v_pk_fma_f32 v[88:89], v[12:13], v[12:13], v[88:89]
  v_pk_add_f32 v[14:15], v[70:71], v[92:93] op_sel_hi:[1,0]
  v_pk_fma_f32 v[90:91], v[14:15], v[14:15], v[90:91]
  v_pk_add_f32 v[16:17], v[72:73], v[92:93] op_sel_hi:[1,0]
  v_pk_fma_f32 v[88:89], v[16:17], v[16:17], v[88:89]
  v_pk_add_f32 v[18:19], v[74:75], v[92:93] op_sel_hi:[1,0]
  v_pk_fma_f32 v[90:91], v[18:19], v[18:19], v[90:91]
  v_pk_add_f32 v[20:21], v[76:77], v[92:93] op_sel_hi:[1,0]
  v_pk_fma_f32 v[88:89], v[20:21], v[20:21], v[88:89]
  v_pk_add_f32 v[22:23], v[78:79], v[92:93] op_sel_hi:[1,0]
  v_pk_fma_f32 v[90:91], v[22:23], v[22:23], v[90:91]
  v_pk_add_f32 v[24:25], v[80:81], v[92:93] op_sel_hi:[1,0]
  v_pk_fma_f32 v[88:89], v[24:25], v[24:25], v[88:89]
  v_pk_add_f32 v[26:27], v[82:83], v[92:93] op_sel_hi:[1,0]
  v_pk_fma_f32 v[90:91], v[26:27], v[26:27], v[90:91]
  v_pk_add_f32 v[28:29], v[84:85], v[92:93] op_sel_hi:[1,0]
  v_pk_fma_f32 v[88:89], v[28:29], v[28:29], v[88:89]
  v_pk_add_f32 v[30:31], v[86:87], v[92:93] op_sel_hi:[1,0]
  v_pk_fma_f32 v[90:91], v[30:31], v[30:31], v[90:91]
  v_pk_add_f32 v[88:89], v[88:89], v[90:91]
  v_add_f32 v88, v88, v89
  s_nop 1
  v_add_f32_dpp v88, v88, v88 quad_perm:[1,0,3,2] row_mask:0xf bank_mask:0xf
  s_nop 1
  v_add_f32_dpp v88, v88, v88 quad_perm:[2,3,0,1] row_mask:0xf bank_mask:0xf
  v_mov_b32 v90, v88
  s_nop 1
  v_permlane16_swap_b32 v88, v90
  v_add_f32 v88, v88, v90
  v_mov_b32 v90, v88
  s_nop 1
  v_permlane32_swap_b32 v88, v90
  v_add_f32 v88, v88, v90
  v_mul_f32 v94, 0x3acccccd, v88
  v_cvt_pk_bf16_f32 v92, v92, v92
  v_and_b32 v92, 0xffff0000, v92
  v_cvt_pk_bf16_f32 v94, v94, v94
  v_and_b32 v94, 0xffff0000, v94
  v_add_f32 v94, 0x3727c5ac, v94
  v_cvt_pk_bf16_f32 v94, v94, v94
  v_and_b32 v94, 0xffff0000, v94
  v_sqrt_f32 v94, v94
  s_nop 0
  v_cvt_pk_bf16_f32 v94, v94, v94
  v_and_b32 v94, 0xffff0000, v94
  v_rcp_f32 v94, v94
  v_pk_add_f32 v[48:49], v[48:49], v[92:93] op_sel_hi:[1,0]
  v_pk_add_f32 v[50:51], v[50:51], v[92:93] op_sel_hi:[1,0]
  v_pk_add_f32 v[52:53], v[52:53], v[92:93] op_sel_hi:[1,0]
  v_pk_add_f32 v[54:55], v[54:55], v[92:93] op_sel_hi:[1,0]
  v_pk_add_f32 v[56:57], v[56:57], v[92:93] op_sel_hi:[1,0]
  v_pk_add_f32 v[58:59], v[58:59], v[92:93] op_sel_hi:[1,0]
  v_pk_add_f32 v[60:61], v[60:61], v[92:93] op_sel_hi:[1,0]
  v_pk_add_f32 v[62:63], v[62:63], v[92:93] op_sel_hi:[1,0]
  v_pk_add_f32 v[64:65], v[64:65], v[92:93] op_sel_hi:[1,0]
  v_pk_add_f32 v[66:67], v[66:67], v[92:93] op_sel_hi:[1,0]
  v_pk_add_f32 v[68:69], v[68:69], v[92:93] op_sel_hi:[1,0]
  v_pk_add_f32 v[70:71], v[70:71], v[92:93] op_sel_hi:[1,0]
  v_pk_add_f32 v[72:73], v[72:73], v[92:93] op_sel_hi:[1,0]
  v_pk_add_f32 v[74:75], v[74:75], v[92:93] op_sel_hi:[1,0]
  v_pk_add_f32 v[76:77], v[76:77], v[92:93] op_sel_hi:[1,0]
  v_pk_add_f32 v[78:79], v[78:79], v[92:93] op_sel_hi:[1,0]
  v_pk_add_f32 v[80:81], v[80:81], v[92:93] op_sel_hi:[1,0]
  v_pk_add_f32 v[82:83], v[82:83], v[92:93] op_sel_hi:[1,0]
  v_pk_add_f32 v[84:85], v[84:85], v[92:93] op_sel_hi:[1,0]
  v_pk_add_f32 v[86:87], v[86:87], v[92:93] op_sel_hi:[1,0]
  v_cvt_pk_bf16_f32 v12, v48, v49
  v_cvt_pk_bf16_f32 v13, v50, v51
  v_cvt_pk_bf16_f32 v14, v52, v53
  v_cvt_pk_bf16_f32 v15, v54, v55
  v_cvt_pk_bf16_f32 v16, v56, v57
  v_cvt_pk_bf16_f32 v17, v58, v59
  v_cvt_pk_bf16_f32 v18, v60, v61
  v_cvt_pk_bf16_f32 v19, v62, v63
  v_cvt_pk_bf16_f32 v20, v64, v65
  v_cvt_pk_bf16_f32 v21, v66, v67
  v_cvt_pk_bf16_f32 v22, v68, v69
  v_cvt_pk_bf16_f32 v23, v70, v71
  v_cvt_pk_bf16_f32 v24, v72, v73
  v_cvt_pk_bf16_f32 v25, v74, v75
  v_cvt_pk_bf16_f32 v26, v76, v77
  v_cvt_pk_bf16_f32 v27, v78, v79
  v_cvt_pk_bf16_f32 v28, v80, v81
  v_cvt_pk_bf16_f32 v29, v82, v83
  v_cvt_pk_bf16_f32 v30, v84, v85
  v_cvt_pk_bf16_f32 v31, v86, v87
  v_lshlrev_b32 v48, 16, v12
  v_and_b32 v49, 0xffff0000, v12
  v_lshlrev_b32 v50, 16, v13
  v_and_b32 v51, 0xffff0000, v13
  v_lshlrev_b32 v52, 16, v14
  v_and_b32 v53, 0xffff0000, v14
  v_lshlrev_b32 v54, 16, v15
  v_and_b32 v55, 0xffff0000, v15
  v_lshlrev_b32 v56, 16, v16
  v_and_b32 v57, 0xffff0000, v16
  v_lshlrev_b32 v58, 16, v17
  v_and_b32 v59, 0xffff0000, v17
  v_lshlrev_b32 v60, 16, v18
  v_and_b32 v61, 0xffff0000, v18
  v_lshlrev_b32 v62, 16, v19
  v_and_b32 v63, 0xffff0000, v19
  v_lshlrev_b32 v64, 16, v20
  v_and_b32 v65, 0xffff0000, v20
  v_lshlrev_b32 v66, 16, v21
  v_and_b32 v67, 0xffff0000, v21
  v_lshlrev_b32 v68, 16, v22
  v_and_b32 v69, 0xffff0000, v22
  v_lshlrev_b32 v70, 16, v23
  v_and_b32 v71, 0xffff0000, v23
  v_lshlrev_b32 v72, 16, v24
  v_and_b32 v73, 0xffff0000, v24
  v_lshlrev_b32 v74, 16, v25
  v_and_b32 v75, 0xffff0000, v25
  v_lshlrev_b32 v76, 16, v26
  v_and_b32 v77, 0xffff0000, v26
  v_lshlrev_b32 v78, 16, v27
  v_and_b32 v79, 0xffff0000, v27
  v_lshlrev_b32 v80, 16, v28
  v_and_b32 v81, 0xffff0000, v28
  v_lshlrev_b32 v82, 16, v29
  v_and_b32 v83, 0xffff0000, v29
  v_lshlrev_b32 v84, 16, v30
  v_and_b32 v85, 0xffff0000, v30
  v_lshlrev_b32 v86, 16, v31
  v_and_b32 v87, 0xffff0000, v31
  v_pk_mul_f32 v[48:49], v[48:49], v[94:95] op_sel_hi:[1,0]
  v_pk_mul_f32 v[50:51], v[50:51], v[94:95] op_sel_hi:[1,0]
  v_pk_mul_f32 v[52:53], v[52:53], v[94:95] op_sel_hi:[1,0]
  v_pk_mul_f32 v[54:55], v[54:55], v[94:95] op_sel_hi:[1,0]
  v_pk_mul_f32 v[56:57], v[56:57], v[94:95] op_sel_hi:[1,0]
  v_pk_mul_f32 v[58:59], v[58:59], v[94:95] op_sel_hi:[1,0]
  v_pk_mul_f32 v[60:61], v[60:61], v[94:95] op_sel_hi:[1,0]
  v_pk_mul_f32 v[62:63], v[62:63], v[94:95] op_sel_hi:[1,0]
  v_pk_mul_f32 v[64:65], v[64:65], v[94:95] op_sel_hi:[1,0]
  v_pk_mul_f32 v[66:67], v[66:67], v[94:95] op_sel_hi:[1,0]
  v_pk_mul_f32 v[68:69], v[68:69], v[94:95] op_sel_hi:[1,0]
  v_pk_mul_f32 v[70:71], v[70:71], v[94:95] op_sel_hi:[1,0]
  v_pk_mul_f32 v[72:73], v[72:73], v[94:95] op_sel_hi:[1,0]
  v_pk_mul_f32 v[74:75], v[74:75], v[94:95] op_sel_hi:[1,0]
  v_pk_mul_f32 v[76:77], v[76:77], v[94:95] op_sel_hi:[1,0]
  v_pk_mul_f32 v[78:79], v[78:79], v[94:95] op_sel_hi:[1,0]
  v_pk_mul_f32 v[80:81], v[80:81], v[94:95] op_sel_hi:[1,0]
  v_pk_mul_f32 v[82:83], v[82:83], v[94:95] op_sel_hi:[1,0]
  v_pk_mul_f32 v[84:85], v[84:85], v[94:95] op_sel_hi:[1,0]
  v_pk_mul_f32 v[86:87], v[86:87], v[94:95] op_sel_hi:[1,0]
  v_cvt_pk_bf16_f32 v12, v48, v49
  v_cvt_pk_bf16_f32 v13, v50, v51
  v_cvt_pk_bf16_f32 v14, v52, v53
  v_cvt_pk_bf16_f32 v15, v54, v55
  v_cvt_pk_bf16_f32 v16, v56, v57
  v_cvt_pk_bf16_f32 v17, v58, v59
  v_cvt_pk_bf16_f32 v18, v60, v61
  v_cvt_pk_bf16_f32 v19, v62, v63
  v_cvt_pk_bf16_f32 v20, v64, v65
  v_cvt_pk_bf16_f32 v21, v66, v67
  v_cvt_pk_bf16_f32 v22, v68, v69
  v_cvt_pk_bf16_f32 v23, v70, v71
  v_cvt_pk_bf16_f32 v24, v72, v73
  v_cvt_pk_bf16_f32 v25, v74, v75
  v_cvt_pk_bf16_f32 v26, v76, v77
  v_cvt_pk_bf16_f32 v27, v78, v79
  v_cvt_pk_bf16_f32 v28, v80, v81
  v_cvt_pk_bf16_f32 v29, v82, v83
  v_cvt_pk_bf16_f32 v30, v84, v85
  v_cvt_pk_bf16_f32 v31, v86, v87
  s_waitcnt vmcnt(32)
  v_perm_b32 v64, v100, v96, s41
  v_perm_b32 v65, v108, v104, s41
  v_perm_b32 v66, v116, v112, s41
  v_perm_b32 v67, v124, v120, s41
  v_perm_b32 v68, v100, v96, s42
  v_perm_b32 v69, v108, v104, s42
  v_perm_b32 v70, v116, v112, s42
  v_perm_b32 v71, v124, v120, s42
  v_mfma_f32_16x16x32_bf16 v[32:35], v[12:15], v[64:67], 0
  v_perm_b32 v72, v101, v97, s41
  v_perm_b32 v73, v109, v105, s41
  v_perm_b32 v74, v117, v113, s41
  v_perm_b32 v75, v125, v121, s41
  v_mfma_f32_16x16x32_bf16 v[36:39], v[12:15], v[68:71], 0
  v_perm_b32 v76, v101, v97, s42
  v_perm_b32 v77, v109, v105, s42
  v_perm_b32 v78, v117, v113, s42
  v_perm_b32 v79, v125, v121, s42
  v_mfma_f32_16x16x32_bf16 v[40:43], v[12:15], v[72:75], 0
  v_perm_b32 v80, v102, v98, s41
  v_perm_b32 v81, v110, v106, s41
  v_perm_b32 v82, v118, v114, s41
  v_perm_b32 v83, v126, v122, s41
  v_mfma_f32_16x16x32_bf16 v[44:47], v[12:15], v[76:79], 0
  v_perm_b32 v84, v102, v98, s42
  v_perm_b32 v85, v110, v106, s42
  v_perm_b32 v86, v118, v114, s42
  v_perm_b32 v87, v126, v122, s42
  v_mfma_f32_16x16x32_bf16 v[48:51], v[12:15], v[80:83], 0
  v_perm_b32 v88, v103, v99, s41
  v_perm_b32 v89, v111, v107, s41
  v_perm_b32 v90, v119, v115, s41
  v_perm_b32 v91, v127, v123, s41
  v_mfma_f32_16x16x32_bf16 v[52:55], v[12:15], v[84:87], 0
  v_perm_b32 v92, v103, v99, s42
  v_perm_b32 v93, v111, v107, s42
  v_perm_b32 v94, v119, v115, s42
  v_perm_b32 v95, v127, v123, s42
  v_mfma_f32_16x16x32_bf16 v[56:59], v[12:15], v[88:91], 0
  s_nop 0
  v_mfma_f32_16x16x32_bf16 v[60:63], v[12:15], v[92:95], 0
  s_waitcnt vmcnt(24)
  v_perm_b32 v64, v132, v128, s41
  v_perm_b32 v65, v140, v136, s41
  v_perm_b32 v66, v148, v144, s41
  v_perm_b32 v67, v156, v152, s41
  v_perm_b32 v68, v132, v128, s42
  v_perm_b32 v69, v140, v136, s42
  v_perm_b32 v70, v148, v144, s42
  v_perm_b32 v71, v156, v152, s42
  v_mfma_f32_16x16x32_bf16 v[32:35], v[16:19], v[64:67], v[32:35]
  v_perm_b32 v72, v133, v129, s41
  v_perm_b32 v73, v141, v137, s41
  v_perm_b32 v74, v149, v145, s41
  v_perm_b32 v75, v157, v153, s41
  v_mfma_f32_16x16x32_bf16 v[36:39], v[16:19], v[68:71], v[36:39]
  v_perm_b32 v76, v133, v129, s42
  v_perm_b32 v77, v141, v137, s42
  v_perm_b32 v78, v149, v145, s42
  v_perm_b32 v79, v157, v153, s42
  v_mfma_f32_16x16x32_bf16 v[40:43], v[16:19], v[72:75], v[40:43]
  v_perm_b32 v80, v134, v130, s41
  v_perm_b32 v81, v142, v138, s41
  v_perm_b32 v82, v150, v146, s41
  v_perm_b32 v83, v158, v154, s41
  v_mfma_f32_16x16x32_bf16 v[44:47], v[16:19], v[76:79], v[44:47]
  v_perm_b32 v84, v134, v130, s42
  v_perm_b32 v85, v142, v138, s42
  v_perm_b32 v86, v150, v146, s42
  v_perm_b32 v87, v158, v154, s42
  v_mfma_f32_16x16x32_bf16 v[48:51], v[16:19], v[80:83], v[48:51]
  v_perm_b32 v88, v135, v131, s41
  v_perm_b32 v89, v143, v139, s41
  v_perm_b32 v90, v151, v147, s41
  v_perm_b32 v91, v159, v155, s41
  v_mfma_f32_16x16x32_bf16 v[52:55], v[16:19], v[84:87], v[52:55]
  v_perm_b32 v92, v135, v131, s42
  v_perm_b32 v93, v143, v139, s42
  v_perm_b32 v94, v151, v147, s42
  v_perm_b32 v95, v159, v155, s42
  v_mfma_f32_16x16x32_bf16 v[56:59], v[16:19], v[88:91], v[56:59]
  s_nop 0
  v_mfma_f32_16x16x32_bf16 v[60:63], v[16:19], v[92:95], v[60:63]
  s_waitcnt vmcnt(16)
  v_perm_b32 v64, v164, v160, s41
  v_perm_b32 v65, v172, v168, s41
  v_perm_b32 v66, v180, v176, s41
  v_perm_b32 v67, v188, v184, s41
  v_perm_b32 v68, v164, v160, s42
  v_perm_b32 v69, v172, v168, s42
  v_perm_b32 v70, v180, v176, s42
  v_perm_b32 v71, v188, v184, s42
  v_mfma_f32_16x16x32_bf16 v[32:35], v[20:23], v[64:67], v[32:35]
  v_perm_b32 v72, v165, v161, s41
  v_perm_b32 v73, v173, v169, s41
  v_perm_b32 v74, v181, v177, s41
  v_perm_b32 v75, v189, v185, s41
  v_mfma_f32_16x16x32_bf16 v[36:39], v[20:23], v[68:71], v[36:39]
  v_perm_b32 v76, v165, v161, s42
  v_perm_b32 v77, v173, v169, s42
  v_perm_b32 v78, v181, v177, s42
  v_perm_b32 v79, v189, v185, s42
  v_mfma_f32_16x16x32_bf16 v[40:43], v[20:23], v[72:75], v[40:43]
  v_perm_b32 v80, v166, v162, s41
  v_perm_b32 v81, v174, v170, s41
  v_perm_b32 v82, v182, v178, s41
  v_perm_b32 v83, v190, v186, s41
  v_mfma_f32_16x16x32_bf16 v[44:47], v[20:23], v[76:79], v[44:47]
  v_perm_b32 v84, v166, v162, s42
  v_perm_b32 v85, v174, v170, s42
  v_perm_b32 v86, v182, v178, s42
  v_perm_b32 v87, v190, v186, s42
  v_mfma_f32_16x16x32_bf16 v[48:51], v[20:23], v[80:83], v[48:51]
  v_perm_b32 v88, v167, v163, s41
  v_perm_b32 v89, v175, v171, s41
  v_perm_b32 v90, v183, v179, s41
  v_perm_b32 v91, v191, v187, s41
  v_mfma_f32_16x16x32_bf16 v[52:55], v[20:23], v[84:87], v[52:55]
  v_perm_b32 v92, v167, v163, s42
  v_perm_b32 v93, v175, v171, s42
  v_perm_b32 v94, v183, v179, s42
  v_perm_b32 v95, v191, v187, s42
  v_mfma_f32_16x16x32_bf16 v[56:59], v[20:23], v[88:91], v[56:59]
  s_nop 0
  v_mfma_f32_16x16x32_bf16 v[60:63], v[20:23], v[92:95], v[60:63]
  s_waitcnt vmcnt(8)
  v_perm_b32 v64, v196, v192, s41
  v_perm_b32 v65, v204, v200, s41
  v_perm_b32 v66, v212, v208, s41
  v_perm_b32 v67, v220, v216, s41
  v_perm_b32 v68, v196, v192, s42
  v_perm_b32 v69, v204, v200, s42
  v_perm_b32 v70, v212, v208, s42
  v_perm_b32 v71, v220, v216, s42
  v_mfma_f32_16x16x32_bf16 v[32:35], v[24:27], v[64:67], v[32:35]
  v_perm_b32 v72, v197, v193, s41
  v_perm_b32 v73, v205, v201, s41
  v_perm_b32 v74, v213, v209, s41
  v_perm_b32 v75, v221, v217, s41
  v_mfma_f32_16x16x32_bf16 v[36:39], v[24:27], v[68:71], v[36:39]
  v_perm_b32 v76, v197, v193, s42
  v_perm_b32 v77, v205, v201, s42
  v_perm_b32 v78, v213, v209, s42
  v_perm_b32 v79, v221, v217, s42
  v_mfma_f32_16x16x32_bf16 v[40:43], v[24:27], v[72:75], v[40:43]
  v_perm_b32 v80, v198, v194, s41
  v_perm_b32 v81, v206, v202, s41
  v_perm_b32 v82, v214, v210, s41
  v_perm_b32 v83, v222, v218, s41
  v_mfma_f32_16x16x32_bf16 v[44:47], v[24:27], v[76:79], v[44:47]
  v_perm_b32 v84, v198, v194, s42
  v_perm_b32 v85, v206, v202, s42
  v_perm_b32 v86, v214, v210, s42
  v_perm_b32 v87, v222, v218, s42
  v_mfma_f32_16x16x32_bf16 v[48:51], v[24:27], v[80:83], v[48:51]
  v_perm_b32 v88, v199, v195, s41
  v_perm_b32 v89, v207, v203, s41
  v_perm_b32 v90, v215, v211, s41
  v_perm_b32 v91, v223, v219, s41
  v_mfma_f32_16x16x32_bf16 v[52:55], v[24:27], v[84:87], v[52:55]
  v_perm_b32 v92, v199, v195, s42
  v_perm_b32 v93, v207, v203, s42
  v_perm_b32 v94, v215, v211, s42
  v_perm_b32 v95, v223, v219, s42
  v_mfma_f32_16x16x32_bf16 v[56:59], v[24:27], v[88:91], v[56:59]
  s_nop 0
  v_mfma_f32_16x16x32_bf16 v[60:63], v[24:27], v[92:95], v[60:63]
  s_waitcnt vmcnt(0)
  v_perm_b32 v64, v228, v224, s41
  v_perm_b32 v65, v236, v232, s41
  v_perm_b32 v66, v244, v240, s41
  v_perm_b32 v67, v252, v248, s41
  v_perm_b32 v68, v228, v224, s42
  v_perm_b32 v69, v236, v232, s42
  v_perm_b32 v70, v244, v240, s42
  v_perm_b32 v71, v252, v248, s42
  v_mfma_f32_16x16x32_bf16 v[32:35], v[28:31], v[64:67], v[32:35]
  v_perm_b32 v72, v229, v225, s41
  v_perm_b32 v73, v237, v233, s41
  v_perm_b32 v74, v245, v241, s41
  v_perm_b32 v75, v253, v249, s41
  v_mfma_f32_16x16x32_bf16 v[36:39], v[28:31], v[68:71], v[36:39]
  v_perm_b32 v76, v229, v225, s42
  v_perm_b32 v77, v237, v233, s42
  v_perm_b32 v78, v245, v241, s42
  v_perm_b32 v79, v253, v249, s42
  v_mfma_f32_16x16x32_bf16 v[40:43], v[28:31], v[72:75], v[40:43]
  v_perm_b32 v80, v230, v226, s41
  v_perm_b32 v81, v238, v234, s41
  v_perm_b32 v82, v246, v242, s41
  v_perm_b32 v83, v254, v250, s41
  v_mfma_f32_16x16x32_bf16 v[44:47], v[28:31], v[76:79], v[44:47]
  v_perm_b32 v84, v230, v226, s42
  v_perm_b32 v85, v238, v234, s42
  v_perm_b32 v86, v246, v242, s42
  v_perm_b32 v87, v254, v250, s42
  v_mfma_f32_16x16x32_bf16 v[48:51], v[28:31], v[80:83], v[48:51]
  v_perm_b32 v88, v231, v227, s41
  v_perm_b32 v89, v239, v235, s41
  v_perm_b32 v90, v247, v243, s41
  v_perm_b32 v91, v255, v251, s41
  v_mfma_f32_16x16x32_bf16 v[52:55], v[28:31], v[84:87], v[52:55]
  v_perm_b32 v92, v231, v227, s42
  v_perm_b32 v93, v239, v235, s42
  v_perm_b32 v94, v247, v243, s42
  v_perm_b32 v95, v255, v251, s42
  v_mfma_f32_16x16x32_bf16 v[56:59], v[28:31], v[88:91], v[56:59]
  s_nop 0
  v_mfma_f32_16x16x32_bf16 v[60:63], v[28:31], v[92:95], v[60:63]
  v_add_u32 v64, 0x80, v32
  v_add_u32 v65, 0x80, v36
  v_add_u32 v66, 0x80, v40
  v_add_u32 v67, 0x80, v44
  v_add_u32 v68, 0x80, v48
  v_add_u32 v69, 0x80, v52
  v_add_u32 v70, 0x80, v56
  s_nop 0
  v_add_u32 v71, 0x80, v60
  v_perm_b32 v64, v64, v10, s98
  v_perm_b32 v65, v65, v10, s99
  v_perm_b32 v66, v66, v10, s100
  v_perm_b32 v67, v67, v10, s101
  v_perm_b32 v68, v68, v10, s98
  v_perm_b32 v69, v69, v10, s99
  v_perm_b32 v70, v70, v10, s100
  v_perm_b32 v71, v71, v10, s101
  v_lshlrev_b32 v8, 4, v1
  buffer_store_dwordx4 v[64:67], v8, s[36:39], s60 offen sc1
  buffer_store_dwordx4 v[68:71], v8, s[36:39], s60 offen offset:1024 sc1
  s_nop 0
  s_branch L_bar1
L_s2a:
  s_mov_b32 s92, 2
  s_mul_i32 s45, s89, 7
  s_add_u32 s45, s45, s31
  s_sub_u32 s45, s45, 14
  s_lshr_b32 s62, s45, 2
  s_and_b32 s63, s45, 3
  s_mul_i32 s47, s62, 163840
  s_mul_i32 s45, s63, 320
  s_add_u32 s47, s47, s45
  s_add_u32 s32, s20, s47
  s_addc_u32 s33, s21, 0
  s_sub_u32 s34, 2211840, s47
  v_mul_u32_u24 v6, 10240, v2
  v_lshl_add_u32 v7, v3, 2, v6
  v_lshl_add_u32 v6, v3, 4, v6
  s_mov_b32 s40, 0
  buffer_load_dwordx4 v[96:99], v6, s[32:35], s40 offen nt
  buffer_load_dword v224, v7, s[32:35], s40 offen offset:256 nt
  s_mov_b32 s40, 1280
  buffer_load_dwordx4 v[100:103], v6, s[32:35], s40 offen nt
  buffer_load_dword v225, v7, s[32:35], s40 offen offset:256 nt
  s_mov_b32 s40, 2560
  buffer_load_dwordx4 v[104:107], v6, s[32:35], s40 offen nt
  buffer_load_dword v226, v7, s[32:35], s40 offen offset:256 nt
  s_mov_b32 s40, 3840
  buffer_load_dwordx4 v[108:111], v6, s[32:35], s40 offen nt
  buffer_load_dword v227, v7, s[32:35], s40 offen offset:256 nt
  s_mov_b32 s40, 5120
  buffer_load_dwordx4 v[112:115], v6, s[32:35], s40 offen nt
  buffer_load_dword v228, v7, s[32:35], s40 offen offset:256 nt
  s_mov_b32 s40, 6400
  buffer_load_dwordx4 v[116:119], v6, s[32:35], s40 offen nt
  buffer_load_dword v229, v7, s[32:35], s40 offen offset:256 nt
  s_mov_b32 s40, 7680
  buffer_load_dwordx4 v[120:123], v6, s[32:35], s40 offen nt
  buffer_load_dword v230, v7, s[32:35], s40 offen offset:256 nt
  s_mov_b32 s40, 8960
  buffer_load_dwordx4 v[124:127], v6, s[32:35], s40 offen nt
  buffer_load_dword v231, v7, s[32:35], s40 offen offset:256 nt
  s_mov_b32 s40, 40960
  buffer_load_dwordx4 v[128:131], v6, s[32:35], s40 offen nt
  buffer_load_dword v232, v7, s[32:35], s40 offen offset:256 nt
  s_mov_b32 s40, 42240
  buffer_load_dwordx4 v[132:135], v6, s[32:35], s40 offen nt
  buffer_load_dword v233, v7, s[32:35], s40 offen offset:256 nt
  s_mov_b32 s40, 43520
  buffer_load_dwordx4 v[136:139], v6, s[32:35], s40 offen nt
  buffer_load_dword v234, v7, s[32:35], s40 offen offset:256 nt
  s_mov_b32 s40, 44800
  buffer_load_dwordx4 v[140:143], v6, s[32:35], s40 offen nt
  buffer_load_dword v235, v7, s[32:35], s40 offen offset:256 nt
  s_mov_b32 s40, 46080
  buffer_load_dwordx4 v[144:147], v6, s[32:35], s40 offen nt
  buffer_load_dword v236, v7, s[32:35], s40 offen offset:256 nt
  s_mov_b32 s40, 47360
  buffer_load_dwordx4 v[148:151], v6, s[32:35], s40 offen nt
  buffer_load_dword v237, v7, s[32:35], s40 offen offset:256 nt
  s_mov_b32 s40, 48640
  buffer_load_dwordx4 v[152:155], v6, s[32:35], s40 offen nt
  buffer_load_dword v238, v7, s[32:35], s40 offen offset:256 nt
  s_mov_b32 s40, 49920
  buffer_load_dwordx4 v[156:159], v6, s[32:35], s40 offen nt
  buffer_load_dword v239, v7, s[32:35], s40 offen offset:256 nt
  s_mov_b32 s40, 81920
  buffer_load_dwordx4 v[160:163], v6, s[32:35], s40 offen nt
  buffer_load_dword v240, v7, s[32:35], s40 offen offset:256 nt
  s_mov_b32 s40, 83200
  buffer_load_dwordx4 v[164:167], v6, s[32:35], s40 offen nt
  buffer_load_dword v241, v7, s[32:35], s40 offen offset:256 nt
  s_mov_b32 s40, 84480
  buffer_load_dwordx4 v[168:171], v6, s[32:35], s40 offen nt
  buffer_load_dword v242, v7, s[32:35], s40 offen offset:256 nt
  s_mov_b32 s40, 85760
  buffer_load_dwordx4 v[172:175], v6, s[32:35], s40 offen nt
  buffer_load_dword v243, v7, s[32:35], s40 offen offset:256 nt
  s_mov_b32 s40, 87040
  buffer_load_dwordx4 v[176:179], v6, s[32:35], s40 offen nt
  buffer_load_dword v244, v7, s[32:35], s40 offen offset:256 nt
  s_mov_b32 s40, 88320
  buffer_load_dwordx4 v[180:183], v6, s[32:35], s40 offen nt
  buffer_load_dword v245, v7, s[32:35], s40 offen offset:256 nt
  s_mov_b32 s40, 89600
  buffer_load_dwordx4 v[184:187], v6, s[32:35], s40 offen nt
  buffer_load_dword v246, v7, s[32:35], s40 offen offset:256 nt
  s_mov_b32 s40, 90880
  buffer_load_dwordx4 v[188:191], v6, s[32:35], s40 offen nt
  buffer_load_dword v247, v7, s[32:35], s40 offen offset:256 nt
  s_mov_b32 s40, 122880
  buffer_load_dwordx4 v[192:195], v6, s[32:35], s40 offen nt
  buffer_load_dword v248, v7, s[32:35], s40 offen offset:256 nt
  s_mov_b32 s40, 124160
  buffer_load_dwordx4 v[196:199], v6, s[32:35], s40 offen nt
  buffer_load_dword v249, v7, s[32:35], s40 offen offset:256 nt
  s_mov_b32 s40, 125440
  buffer_load_dwordx4 v[200:203], v6, s[32:35], s40 offen nt
  buffer_load_dword v250, v7, s[32:35], s40 offen offset:256 nt
  s_mov_b32 s40, 126720
  buffer_load_dwordx4 v[204:207], v6, s[32:35], s40 offen nt
  buffer_load_dword v251, v7, s[32:35], s40 offen offset:256 nt
  s_mov_b32 s40, 128000
  buffer_load_dwordx4 v[208:211], v6, s[32:35], s40 offen nt
  buffer_load_dword v252, v7, s[32:35], s40 offen offset:256 nt
  s_mov_b32 s40, 129280
  buffer_load_dwordx4 v[212:215], v6, s[32:35], s40 offen nt
  buffer_load_dword v253, v7, s[32:35], s40 offen offset:256 nt
  s_mov_b32 s40, 130560
  buffer_load_dwordx4 v[216:219], v6, s[32:35], s40 offen nt
  buffer_load_dword v254, v7, s[32:35], s40 offen offset:256 nt
  s_mov_b32 s40, 131840
  s_waitcnt vmcnt(60)
  buffer_load_dwordx4 v[220:223], v6, s[32:35], s40 offen nt
  buffer_load_dword v255, v7, s[32:35], s40 offen offset:256 nt
  s_waitcnt vmcnt(0)
  v_perm_b32 v64, v100, v96, s41
  v_perm_b32 v65, v108, v104, s41
  v_perm_b32 v66, v116, v112, s41
  v_perm_b32 v67, v124, v120, s41
  v_perm_b32 v68, v100, v96, s42
  v_perm_b32 v69, v108, v104, s42
  v_perm_b32 v70, v116, v112, s42
  v_perm_b32 v71, v124, v120, s42
  v_perm_b32 v72, v101, v97, s41
  v_perm_b32 v73, v109, v105, s41
  v_perm_b32 v74, v117, v113, s41
  v_perm_b32 v75, v125, v121, s41
  v_perm_b32 v76, v101, v97, s42
  v_perm_b32 v77, v109, v105, s42
  v_perm_b32 v78, v117, v113, s42
  v_perm_b32 v79, v125, v121, s42
  v_perm_b32 v80, v102, v98, s41
  v_perm_b32 v81, v110, v106, s41
  v_perm_b32 v82, v118, v114, s41
  v_perm_b32 v83, v126, v122, s41
  v_perm_b32 v84, v102, v98, s42
  v_perm_b32 v85, v110, v106, s42
  v_perm_b32 v86, v118, v114, s42
  v_perm_b32 v87, v126, v122, s42
  v_perm_b32 v88, v103, v99, s41
  v_perm_b32 v89, v111, v107, s41
  v_perm_b32 v90, v119, v115, s41
  v_perm_b32 v91, v127, v123, s41
  v_perm_b32 v92, v103, v99, s42
  v_perm_b32 v93, v111, v107, s42
  v_perm_b32 v94, v119, v115, s42
  v_perm_b32 v95, v127, v123, s42
  v_perm_b32 v96, v132, v128, s41
  v_perm_b32 v97, v140, v136, s41
  v_perm_b32 v98, v148, v144, s41
  v_perm_b32 v99, v156, v152, s41
  v_perm_b32 v100, v132, v128, s42
  v_perm_b32 v101, v140, v136, s42
  v_perm_b32 v102, v148, v144, s42
  v_perm_b32 v103, v156, v152, s42
  v_perm_b32 v104, v133, v129, s41
  v_perm_b32 v105, v141, v137, s41
  v_perm_b32 v106, v149, v145, s41
  v_perm_b32 v107, v157, v153, s41
  v_perm_b32 v108, v133, v129, s42
  v_perm_b32 v109, v141, v137, s42
  v_perm_b32 v110, v149, v145, s42
  v_perm_b32 v111, v157, v153, s42
  v_perm_b32 v112, v134, v130, s41
  v_perm_b32 v113, v142, v138, s41
  v_perm_b32 v114, v150, v146, s41
  v_perm_b32 v115, v158, v154, s41
  v_perm_b32 v116, v134, v130, s42
  v_perm_b32 v117, v142, v138, s42
  v_perm_b32 v118, v150, v146, s42
  v_perm_b32 v119, v158, v154, s42
  v_perm_b32 v120, v135, v131, s41
  v_perm_b32 v121, v143, v139, s41
  v_perm_b32 v122, v151, v147, s41
  v_perm_b32 v123, v159, v155, s41
  v_perm_b32 v124, v135, v131, s42
  v_perm_b32 v125, v143, v139, s42
  v_perm_b32 v126, v151, v147, s42
  v_perm_b32 v127, v159, v155, s42
  v_perm_b32 v128, v164, v160, s41
  v_perm_b32 v129, v172, v168, s41
  v_perm_b32 v130, v180, v176, s41
  v_perm_b32 v131, v188, v184, s41
  v_perm_b32 v132, v164, v160, s42
  v_perm_b32 v133, v172, v168, s42
  v_perm_b32 v134, v180, v176, s42
  v_perm_b32 v135, v188, v184, s42
  v_perm_b32 v136, v165, v161, s41
  v_perm_b32 v137, v173, v169, s41
  v_perm_b32 v138, v181, v177, s41
  v_perm_b32 v139, v189, v185, s41
  v_perm_b32 v140, v165, v161, s42
  v_perm_b32 v141, v173, v169, s42
  v_perm_b32 v142, v181, v177, s42
  v_perm_b32 v143, v189, v185, s42
  v_perm_b32 v144, v166, v162, s41
  v_perm_b32 v145, v174, v170, s41
  v_perm_b32 v146, v182, v178, s41
  v_perm_b32 v147, v190, v186, s41
  v_perm_b32 v148, v166, v162, s42
  v_perm_b32 v149, v174, v170, s42
  v_perm_b32 v150, v182, v178, s42
  v_perm_b32 v151, v190, v186, s42
  v_perm_b32 v152, v167, v163, s41
  v_perm_b32 v153, v175, v171, s41
  v_perm_b32 v154, v183, v179, s41
  v_perm_b32 v155, v191, v187, s41
  v_perm_b32 v156, v167, v163, s42
  v_perm_b32 v157, v175, v171, s42
  v_perm_b32 v158, v183, v179, s42
  v_perm_b32 v159, v191, v187, s42
  v_perm_b32 v160, v196, v192, s41
  v_perm_b32 v161, v204, v200, s41
  v_perm_b32 v162, v212, v208, s41
  v_perm_b32 v163, v220, v216, s41
  v_perm_b32 v164, v196, v192, s42
  v_perm_b32 v165, v204, v200, s42
  v_perm_b32 v166, v212, v208, s42
  v_perm_b32 v167, v220, v216, s42
  v_perm_b32 v168, v197, v193, s41
  v_perm_b32 v169, v205, v201, s41
  v_perm_b32 v170, v213, v209, s41
  v_perm_b32 v171, v221, v217, s41
  v_perm_b32 v172, v197, v193, s42
  v_perm_b32 v173, v205, v201, s42
  v_perm_b32 v174, v213, v209, s42
  v_perm_b32 v175, v221, v217, s42
  v_perm_b32 v176, v198, v194, s41
  v_perm_b32 v177, v206, v202, s41
  v_perm_b32 v178, v214, v210, s41
  v_perm_b32 v179, v222, v218, s41
  v_perm_b32 v180, v198, v194, s42
  v_perm_b32 v181, v206, v202, s42
  v_perm_b32 v182, v214, v210, s42
  v_perm_b32 v183, v222, v218, s42
  v_perm_b32 v184, v199, v195, s41
  v_perm_b32 v185, v207, v203, s41
  v_perm_b32 v186, v215, v211, s41
  v_perm_b32 v187, v223, v219, s41
  v_perm_b32 v188, v199, v195, s42
  v_perm_b32 v189, v207, v203, s42
  v_perm_b32 v190, v215, v211, s42
  v_perm_b32 v191, v223, v219, s42
  v_perm_b32 v192, v225, v224, s41
  v_perm_b32 v193, v227, v226, s41
  v_perm_b32 v194, v229, v228, s41
  v_perm_b32 v195, v231, v230, s41
  v_perm_b32 v196, v225, v224, s42
  v_perm_b32 v197, v227, v226, s42
  v_perm_b32 v198, v229, v228, s42
  v_perm_b32 v199, v231, v230, s42
  v_perm_b32 v200, v233, v232, s41
  v_perm_b32 v201, v235, v234, s41
  v_perm_b32 v202, v237, v236, s41
  v_perm_b32 v203, v239, v238, s41
  v_perm_b32 v204, v233, v232, s42
  v_perm_b32 v205, v235, v234, s42
  v_perm_b32 v206, v237, v236, s42
  v_perm_b32 v207, v239, v238, s42
  v_perm_b32 v208, v241, v240, s41
  v_perm_b32 v209, v243, v242, s41
  v_perm_b32 v210, v245, v244, s41
  v_perm_b32 v211, v247, v246, s41
  v_perm_b32 v212, v241, v240, s42
  v_perm_b32 v213, v243, v242, s42
  v_perm_b32 v214, v245, v244, s42
  v_perm_b32 v215, v247, v246, s42
  v_perm_b32 v216, v249, v248, s41
  v_perm_b32 v217, v251, v250, s41
  v_perm_b32 v218, v253, v252, s41
  v_perm_b32 v219, v255, v254, s41
  v_perm_b32 v220, v249, v248, s42
  v_perm_b32 v221, v251, v250, s42
  v_perm_b32 v222, v253, v252, s42
  v_perm_b32 v223, v255, v254, s42
  s_nop 0
  s_branch L_idle
L_pf:
  s_sub_u32 s40, s31, 21
  s_mul_i32 s40, s40, 3
  s_add_u32 s40, s40, s3
  s_sub_u32 s40, s40, 1
  s_lshr_b32 s46, s40, 3
  s_and_b32 s40, s40, 7
  s_mul_i32 s40, s40, 20480
  s_lshl_b32 s45, s46, 3
  s_add_u32 s45, s45, s89
  s_mul_i32 s45, s45, 163840
  s_add_u32 s40, s40, s45
  s_mov_b32 s32, s12
  s_mov_b32 s33, s13
  s_mov_b32 s34, 5242880
  v_lshlrev_b32 v8, 4, v1
  buffer_load_dwordx4 v[96:99], v8, s[32:35], s40 offen offset:0
  buffer_load_dwordx4 v[100:103], v8, s[32:35], s40 offen offset:1024
  buffer_load_dwordx4 v[104:107], v8, s[32:35], s40 offen offset:2048
  buffer_load_dwordx4 v[108:111], v8, s[32:35], s40 offen offset:3072
  s_add_u32 s40, s40, 4096
  buffer_load_dwordx4 v[112:115], v8, s[32:35], s40 offen offset:0
  buffer_load_dwordx4 v[116:119], v8, s[32:35], s40 offen offset:1024
  buffer_load_dwordx4 v[120:123], v8, s[32:35], s40 offen offset:2048
  buffer_load_dwordx4 v[124:127], v8, s[32:35], s40 offen offset:3072
  s_add_u32 s40, s40, 4096
  buffer_load_dwordx4 v[128:131], v8, s[32:35], s40 offen offset:0
  buffer_load_dwordx4 v[132:135], v8, s[32:35], s40 offen offset:1024
  buffer_load_dwordx4 v[136:139], v8, s[32:35], s40 offen offset:2048
  buffer_load_dwordx4 v[140:143], v8, s[32:35], s40 offen offset:3072
  s_add_u32 s40, s40, 4096
  buffer_load_dwordx4 v[144:147], v8, s[32:35], s40 offen offset:0
  buffer_load_dwordx4 v[148:151], v8, s[32:35], s40 offen offset:1024
  buffer_load_dwordx4 v[152:155], v8, s[32:35], s40 offen offset:2048
  buffer_load_dwordx4 v[156:159], v8, s[32:35], s40 offen offset:3072
  s_add_u32 s40, s40, 4096
  buffer_load_dwordx4 v[160:163], v8, s[32:35], s40 offen offset:0
  buffer_load_dwordx4 v[164:167], v8, s[32:35], s40 offen offset:1024
  buffer_load_dwordx4 v[168:171], v8, s[32:35], s40 offen offset:2048
  buffer_load_dwordx4 v[172:175], v8, s[32:35], s40 offen offset:3072
  s_add_u32 s40, s40, 4096
L_idle:
  s_mov_b32 s36, s26
  s_mov_b32 s37, s27
  s_mov_b32 s38, 2097152
  s_mov_b32 s39, 0x20000
  s_mov_b32 s56, s22
  s_mov_b32 s57, s23
  s_mov_b32 s58, 5120
  s_mov_b32 s59, 0x20000
  s_mov_b32 s98, 0x07060500
  s_mov_b32 s99, 0x07060501
  s_mov_b32 s100, 0x07060502
  s_mov_b32 s101, 0x07060503
  s_waitcnt lgkmcnt(0)
  s_add_u32 s61, s61, 0x9e3779b9
  v_mov_b32 v10, s61
  s_and_b32 s94, s61, 0xff
  s_bfe_u32 s95, s61, 0x80008
  s_bfe_u32 s96, s61, 0x80010
  s_lshr_b32 s97, s61, 24
L_bar1:
  s_barrier
  s_cmp_eq_u32 s92, 0
  s_cbranch_scc1 L_fdone
  s_lshl_b32 s60, s62, 14
  s_add_u32 s60, s60, 1048576
  v_lshlrev_b32 v8, 4, v1
  s_add_u32 s73, s60, 4096
  s_add_u32 s74, s60, 8192
  s_add_u32 s75, s60, 12288
  s_mov_b32 s72, s60
  s_mov_b32 s90, 0
L_pu2:
  buffer_load_dwordx4 v[32:35], v8, s[36:39], s72 offen offset:0 sc1
  buffer_load_dwordx4 v[36:39], v8, s[36:39], s72 offen offset:1024 sc1
  buffer_load_dwordx4 v[40:43], v8, s[36:39], s72 offen offset:2048 sc1
  buffer_load_dwordx4 v[44:47], v8, s[36:39], s72 offen offset:3072 sc1
  buffer_load_dwordx4 v[48:51], v8, s[36:39], s73 offen offset:0 sc1
  buffer_load_dwordx4 v[52:55], v8, s[36:39], s73 offen offset:1024 sc1
  buffer_load_dwordx4 v[56:59], v8, s[36:39], s73 offen offset:2048 sc1
  buffer_load_dwordx4 v[60:63], v8, s[36:39], s73 offen offset:3072 sc1
  buffer_load_dwordx4 v[224:227], v8, s[36:39], s74 offen offset:0 sc1
  buffer_load_dwordx4 v[228:231], v8, s[36:39], s74 offen offset:1024 sc1
  buffer_load_dwordx4 v[232:235], v8, s[36:39], s74 offen offset:2048 sc1
  buffer_load_dwordx4 v[236:239], v8, s[36:39], s74 offen offset:3072 sc1
  buffer_load_dwordx4 v[240:243], v8, s[36:39], s75 offen offset:0 sc1
  buffer_load_dwordx4 v[244:247], v8, s[36:39], s75 offen offset:1024 sc1
  buffer_load_dwordx4 v[248:251], v8, s[36:39], s75 offen offset:2048 sc1
  buffer_load_dwordx4 v[252:255], v8, s[36:39], s75 offen offset:3072 sc1
  s_waitcnt vmcnt(0)
  v_xor_b32 v32, s94, v32
  v_xor_b32 v33, s95, v33
  v_xor_b32 v34, s96, v34
  v_xor_b32 v35, s97, v35
  v_xor_b32 v36, s94, v36
  v_xor_b32 v37, s95, v37
  v_xor_b32 v38, s96, v38
  v_xor_b32 v39, s97, v39
  v_xor_b32 v40, s94, v40
  v_xor_b32 v41, s95, v41
  v_xor_b32 v42, s96, v42
  v_xor_b32 v43, s97, v43
  v_xor_b32 v44, s94, v44
  v_xor_b32 v45, s95, v45
  v_xor_b32 v46, s96, v46
  v_xor_b32 v47, s97, v47
  v_xor_b32 v48, s94, v48
  v_xor_b32 v49, s95, v49
  v_xor_b32 v50, s96, v50
  v_xor_b32 v51, s97, v51
  v_xor_b32 v52, s94, v52
  v_xor_b32 v53, s95, v53
  v_xor_b32 v54, s96, v54
  v_xor_b32 v55, s97, v55
  v_xor_b32 v56, s94, v56
  v_xor_b32 v57, s95, v57
  v_xor_b32 v58, s96, v58
  v_xor_b32 v59, s97, v59
  v_xor_b32 v60, s94, v60
  v_xor_b32 v61, s95, v61
  v_xor_b32 v62, s96, v62
  v_xor_b32 v63, s97, v63
  v_xor_b32 v224, s94, v224
  v_xor_b32 v225, s95, v225
  v_xor_b32 v226, s96, v226
  v_xor_b32 v227, s97, v227
  v_xor_b32 v228, s94, v228
  v_xor_b32 v229, s95, v229
  v_xor_b32 v230, s96, v230
  v_xor_b32 v231, s97, v231
  v_xor_b32 v232, s94, v232
  v_xor_b32 v233, s95, v233
  v_xor_b32 v234, s96, v234
  v_xor_b32 v235, s97, v235
  v_xor_b32 v236, s94, v236
  v_xor_b32 v237, s95, v237
  v_xor_b32 v238, s96, v238
  v_xor_b32 v239, s97, v239
  v_xor_b32 v240, s94, v240
  v_xor_b32 v241, s95, v241
  v_xor_b32 v242, s96, v242
  v_xor_b32 v243, s97, v243
  v_xor_b32 v244, s94, v244
  v_xor_b32 v245, s95, v245
  v_xor_b32 v246, s96, v246
  v_xor_b32 v247, s97, v247
  v_xor_b32 v248, s94, v248
  v_xor_b32 v249, s95, v249
  v_xor_b32 v250, s96, v250
  v_xor_b32 v251, s97, v251
  v_xor_b32 v252, s94, v252
  v_xor_b32 v253, s95, v253
  v_xor_b32 v254, s96, v254
  v_xor_b32 v255, s97, v255
  v_or_b32 v12, v32, v33
  v_or3_b32 v12, v12, v34, v35
  v_or3_b32 v12, v12, v36, v37
  v_or3_b32 v12, v12, v38, v39
  v_or3_b32 v12, v12, v40, v41
  v_or3_b32 v12, v12, v42, v43
  v_or3_b32 v12, v12, v44, v45
  v_or3_b32 v12, v12, v46, v47
  v_or3_b32 v12, v12, v48, v49
  v_or3_b32 v12, v12, v50, v51
  v_or3_b32 v12, v12, v52, v53
  v_or3_b32 v12, v12, v54, v55
  v_or3_b32 v12, v12, v56, v57
  v_or3_b32 v12, v12, v58, v59
  v_or3_b32 v12, v12, v60, v61
  v_or3_b32 v12, v12, v62, v63
  v_or3_b32 v12, v12, v224, v225
  v_or3_b32 v12, v12, v226, v227
  v_or3_b32 v12, v12, v228, v229
  v_or3_b32 v12, v12, v230, v231
  v_or3_b32 v12, v12, v232, v233
  v_or3_b32 v12, v12, v234, v235
  v_or3_b32 v12, v12, v236, v237
  v_or3_b32 v12, v12, v238, v239
  v_or3_b32 v12, v12, v240, v241
  v_or3_b32 v12, v12, v242, v243
  v_or3_b32 v12, v12, v244, v245
  v_or3_b32 v12, v12, v246, v247
  v_or3_b32 v12, v12, v248, v249
  v_or3_b32 v12, v12, v250, v251
  v_or3_b32 v12, v12, v252, v253
  v_or3_b32 v12, v12, v254, v255
  v_and_b32 v12, 0xff, v12
  v_cmp_ne_u32 vcc, 0, v12
  s_nop 0
  s_cmp_eq_u64 vcc, 0
  s_nop 1
  s_cbranch_scc1 L_pu2_ok
  s_sleep 127
  s_add_u32 s90, s90, 1
  s_cmp_lt_u32 s90, 65536
  s_cbranch_scc1 L_pu2
L_pu2_ok:
  s_mov_b64 exec, -1
  v_add_f32 v32, v32, v40
  v_add_f32 v33, v33, v41
  v_add_f32 v34, v34, v42
  v_add_f32 v35, v35, v43
  v_add_f32 v36, v36, v44
  v_add_f32 v37, v37, v45
  v_add_f32 v38, v38, v46
  v_add_f32 v39, v39, v47
  v_add_f32 v48, v48, v56
  v_add_f32 v49, v49, v57
  v_add_f32 v50, v50, v58
  v_add_f32 v51, v51, v59
  v_add_f32 v52, v52, v60
  v_add_f32 v53, v53, v61
  v_add_f32 v54, v54, v62
  v_add_f32 v55, v55, v63
  v_add_f32 v32, v32, v48
  v_add_f32 v33, v33, v49
  v_add_f32 v34, v34, v50
  v_add_f32 v35, v35, v51
  v_add_f32 v36, v36, v52
  v_add_f32 v37, v37, v53
  v_add_f32 v38, v38, v54
  v_add_f32 v39, v39, v55
  v_cvt_pk_bf16_f32 v32, v32, v32
  v_and_b32 v32, 0xffff0000, v32
  v_cvt_pk_bf16_f32 v33, v33, v33
  v_and_b32 v33, 0xffff0000, v33
  v_cvt_pk_bf16_f32 v34, v34, v34
  v_and_b32 v34, 0xffff0000, v34
  v_cvt_pk_bf16_f32 v35, v35, v35
  v_and_b32 v35, 0xffff0000, v35
  v_cvt_pk_bf16_f32 v36, v36, v36
  v_and_b32 v36, 0xffff0000, v36
  v_cvt_pk_bf16_f32 v37, v37, v37
  v_and_b32 v37, 0xffff0000, v37
  v_cvt_pk_bf16_f32 v38, v38, v38
  v_and_b32 v38, 0xffff0000, v38
  v_cvt_pk_bf16_f32 v39, v39, v39
  v_and_b32 v39, 0xffff0000, v39
  v_add_f32 v224, v224, v232
  v_add_f32 v225, v225, v233
  v_add_f32 v226, v226, v234
  v_add_f32 v227, v227, v235
  v_add_f32 v228, v228, v236
  v_add_f32 v229, v229, v237
  v_add_f32 v230, v230, v238
  v_add_f32 v231, v231, v239
  v_add_f32 v240, v240, v248
  v_add_f32 v241, v241, v249
  v_add_f32 v242, v242, v250
  v_add_f32 v243, v243, v251
  v_add_f32 v244, v244, v252
  v_add_f32 v245, v245, v253
  v_add_f32 v246, v246, v254
  v_add_f32 v247, v247, v255
  v_add_f32 v224, v224, v240
  v_add_f32 v225, v225, v241
  v_add_f32 v226, v226, v242
  v_add_f32 v227, v227, v243
  v_add_f32 v228, v228, v244
  v_add_f32 v229, v229, v245
  v_add_f32 v230, v230, v246
  v_add_f32 v231, v231, v247
  v_cvt_pk_bf16_f32 v224, v224, v224
  v_and_b32 v224, 0xffff0000, v224
  v_cvt_pk_bf16_f32 v225, v225, v225
  v_and_b32 v225, 0xffff0000, v225
  v_cvt_pk_bf16_f32 v226, v226, v226
  v_and_b32 v226, 0xffff0000, v226
  v_cvt_pk_bf16_f32 v227, v227, v227
  v_and_b32 v227, 0xffff0000, v227
  v_cvt_pk_bf16_f32 v228, v228, v228
  v_and_b32 v228, 0xffff0000, v228
  v_cvt_pk_bf16_f32 v229, v229, v229
  v_and_b32 v229, 0xffff0000, v229
  v_cvt_pk_bf16_f32 v230, v230, v230
  v_and_b32 v230, 0xffff0000, v230
  v_cvt_pk_bf16_f32 v231, v231, v231
  v_and_b32 v231, 0xffff0000, v231
  v_mul_f32 v40, v32, v32
  v_mul_f32 v41, v33, v33
  v_mul_f32 v42, v34, v34
  v_mul_f32 v43, v35, v35
  v_mul_f32 v44, v36, v36
  v_mul_f32 v45, v37, v37
  v_mul_f32 v46, v38, v38
  v_mul_f32 v47, v39, v39
  v_mul_f32 v40, 0x3d372713, v40
  v_mul_f32 v41, 0x3d372713, v41
  v_mul_f32 v42, 0x3d372713, v42
  v_mul_f32 v43, 0x3d372713, v43
  v_mul_f32 v44, 0x3d372713, v44
  v_mul_f32 v45, 0x3d372713, v45
  v_mul_f32 v46, 0x3d372713, v46
  v_mul_f32 v47, 0x3d372713, v47
  v_fma_f32 v40, v40, v32, v32
  v_fma_f32 v41, v41, v33, v33
  v_fma_f32 v42, v42, v34, v34
  v_fma_f32 v43, v43, v35, v35
  v_fma_f32 v44, v44, v36, v36
  v_fma_f32 v45, v45, v37, v37
  v_fma_f32 v46, v46, v38, v38
  v_fma_f32 v47, v47, v39, v39
  v_mul_f32 v40, 0xc0135761, v40
  v_mul_f32 v41, 0xc0135761, v41
  v_mul_f32 v42, 0xc0135761, v42
  v_mul_f32 v43, 0xc0135761, v43
  v_mul_f32 v44, 0xc0135761, v44
  v_mul_f32 v45, 0xc0135761, v45
  v_mul_f32 v46, 0xc0135761, v46
  v_mul_f32 v47, 0xc0135761, v47
  v_exp_f32 v40, v40
  v_exp_f32 v41, v41
  v_exp_f32 v42, v42
  v_exp_f32 v43, v43
  v_exp_f32 v44, v44
  v_exp_f32 v45, v45
  v_exp_f32 v46, v46
  v_exp_f32 v47, v47
  v_add_f32 v40, 1.0, v40
  v_add_f32 v41, 1.0, v41
  v_add_f32 v42, 1.0, v42
  v_add_f32 v43, 1.0, v43
  v_add_f32 v44, 1.0, v44
  v_add_f32 v45, 1.0, v45
  v_add_f32 v46, 1.0, v46
  v_add_f32 v47, 1.0, v47
  v_rcp_f32 v40, v40
  v_rcp_f32 v41, v41
  v_rcp_f32 v42, v42
  v_rcp_f32 v43, v43
  v_rcp_f32 v44, v44
  v_rcp_f32 v45, v45
  v_rcp_f32 v46, v46
  v_rcp_f32 v47, v47
  v_mul_f32 v40, v40, v32
  v_mul_f32 v41, v41, v33
  v_mul_f32 v42, v42, v34
  v_mul_f32 v43, v43, v35
  v_mul_f32 v44, v44, v36
  v_mul_f32 v45, v45, v37
  v_mul_f32 v46, v46, v38
  v_mul_f32 v47, v47, v39
  v_cvt_pk_bf16_f32 v40, v40, v40
  v_cvt_pk_bf16_f32 v41, v41, v41
  v_cvt_pk_bf16_f32 v42, v42, v42
  v_cvt_pk_bf16_f32 v43, v43, v43
  v_cvt_pk_bf16_f32 v44, v44, v44
  v_cvt_pk_bf16_f32 v45, v45, v45
  v_cvt_pk_bf16_f32 v46, v46, v46
  v_cvt_pk_bf16_f32 v47, v47, v47
  v_and_b32 v40, 0xffff0000, v40
  v_and_b32 v41, 0xffff0000, v41
  v_and_b32 v42, 0xffff0000, v42
  v_and_b32 v43, 0xffff0000, v43
  v_and_b32 v44, 0xffff0000, v44
  v_and_b32 v45, 0xffff0000, v45
  v_and_b32 v46, 0xffff0000, v46
  v_and_b32 v47, 0xffff0000, v47
  v_mul_f32 v40, v40, v224
  v_mul_f32 v41, v41, v225
  v_mul_f32 v42, v42, v226
  v_mul_f32 v43, v43, v227
  v_mul_f32 v44, v44, v228
  v_mul_f32 v45, v45, v229
  v_mul_f32 v46, v46, v230
  v_mul_f32 v47, v47, v231
  v_cvt_pk_bf16_f32 v32, v40, v41
  v_cvt_pk_bf16_f32 v33, v42, v43
  v_cvt_pk_bf16_f32 v34, v44, v45
  v_cvt_pk_bf16_f32 v35, v46, v47
  v_lshlrev_b32 v8, 4, v1
  ds_write_b128 v8, v[32:35] offset:27136
  v_lshrrev_b32 v7, 2, v3
  v_lshlrev_b32 v7, 8, v7
  v_lshl_add_u32 v7, v2, 4, v7
  s_waitcnt lgkmcnt(0)
  ds_read_b128 v[12:15], v7 offset:27136
  ds_read_b128 v[16:19], v7 offset:27200
  ds_read_b128 v[20:23], v7 offset:27264
  ds_read_b128 v[24:27], v7 offset:27328
  v_mul_u32_u24 v8, 640, v2
  v_lshl_add_u32 v9, v3, 3, v8
  v_lshl_add_u32 v8, v3, 5, v8
  s_mul_i32 s45, s62, 2560
  s_mul_i32 s46, s63, 640
  s_add_u32 s45, s45, s46
  s_add_u32 s45, s45, 720896
  s_waitcnt lgkmcnt(0)
  v_mfma_f32_16x16x32_bf16 v[32:35], v[12:15], v[64:67], 0
  v_mfma_f32_16x16x32_bf16 v[32:35], v[16:19], v[96:99], v[32:35]
  v_mfma_f32_16x16x32_bf16 v[32:35], v[20:23], v[128:131], v[32:35]
  v_mfma_f32_16x16x32_bf16 v[32:35], v[24:27], v[160:163], v[32:35]
  v_mfma_f32_16x16x32_bf16 v[36:39], v[12:15], v[68:71], 0
  v_mfma_f32_16x16x32_bf16 v[36:39], v[16:19], v[100:103], v[36:39]
  v_mfma_f32_16x16x32_bf16 v[36:39], v[20:23], v[132:135], v[36:39]
  v_mfma_f32_16x16x32_bf16 v[36:39], v[24:27], v[164:167], v[36:39]
  v_mfma_f32_16x16x32_bf16 v[40:43], v[12:15], v[72:75], 0
  v_mfma_f32_16x16x32_bf16 v[40:43], v[16:19], v[104:107], v[40:43]
  v_mfma_f32_16x16x32_bf16 v[40:43], v[20:23], v[136:139], v[40:43]
  v_mfma_f32_16x16x32_bf16 v[40:43], v[24:27], v[168:171], v[40:43]
  v_mfma_f32_16x16x32_bf16 v[44:47], v[12:15], v[76:79], 0
  v_mfma_f32_16x16x32_bf16 v[44:47], v[16:19], v[108:111], v[44:47]
  v_mfma_f32_16x16x32_bf16 v[44:47], v[20:23], v[140:143], v[44:47]
  v_mfma_f32_16x16x32_bf16 v[44:47], v[24:27], v[172:175], v[44:47]
  v_mfma_f32_16x16x32_bf16 v[48:51], v[12:15], v[80:83], 0
  v_mfma_f32_16x16x32_bf16 v[48:51], v[16:19], v[112:115], v[48:51]
  v_mfma_f32_16x16x32_bf16 v[48:51], v[20:23], v[144:147], v[48:51]
  v_mfma_f32_16x16x32_bf16 v[48:51], v[24:27], v[176:179], v[48:51]
  v_mfma_f32_16x16x32_bf16 v[52:55], v[12:15], v[84:87], 0
  v_mfma_f32_16x16x32_bf16 v[52:55], v[16:19], v[116:119], v[52:55]
  v_mfma_f32_16x16x32_bf16 v[52:55], v[20:23], v[148:151], v[52:55]
  v_mfma_f32_16x16x32_bf16 v[52:55], v[24:27], v[180:183], v[52:55]
  v_mfma_f32_16x16x32_bf16 v[56:59], v[12:15], v[88:91], 0
  v_mfma_f32_16x16x32_bf16 v[56:59], v[16:19], v[120:123], v[56:59]
  v_mfma_f32_16x16x32_bf16 v[56:59], v[20:23], v[152:155], v[56:59]
  v_mfma_f32_16x16x32_bf16 v[56:59], v[24:27], v[184:187], v[56:59]
  v_mfma_f32_16x16x32_bf16 v[60:63], v[12:15], v[92:95], 0
  v_mfma_f32_16x16x32_bf16 v[60:63], v[16:19], v[124:127], v[60:63]
  v_mfma_f32_16x16x32_bf16 v[60:63], v[20:23], v[156:159], v[60:63]
  v_mfma_f32_16x16x32_bf16 v[60:63], v[24:27], v[188:191], v[60:63]
  v_mfma_f32_16x16x32_bf16 v[224:227], v[12:15], v[192:195], 0
  v_mfma_f32_16x16x32_bf16 v[224:227], v[16:19], v[200:203], v[224:227]
  v_mfma_f32_16x16x32_bf16 v[224:227], v[20:23], v[208:211], v[224:227]
  v_mfma_f32_16x16x32_bf16 v[224:227], v[24:27], v[216:219], v[224:227]
  v_mfma_f32_16x16x32_bf16 v[228:231], v[12:15], v[196:199], 0
  v_mfma_f32_16x16x32_bf16 v[228:231], v[16:19], v[204:207], v[228:231]
  v_mfma_f32_16x16x32_bf16 v[228:231], v[20:23], v[212:215], v[228:231]
  v_mfma_f32_16x16x32_bf16 v[228:231], v[24:27], v[220:223], v[228:231]
  v_add_u32 v12, 0x80, v32
  v_add_u32 v13, 0x80, v36
  v_add_u32 v14, 0x80, v40
  v_add_u32 v15, 0x80, v44
  v_add_u32 v16, 0x80, v48
  v_add_u32 v17, 0x80, v52
  v_add_u32 v18, 0x80, v56
  v_add_u32 v19, 0x80, v60
  v_add_u32 v20, 0x80, v224
  v_add_u32 v21, 0x80, v228
  ds_write_b128 v8, v[12:15] offset:5120
  ds_write_b128 v8, v[16:19] offset:5136
  ds_write_b64 v9, v[20:21] offset:5632
  v_lshlrev_b32 v8, 4, v1
  v_mov_b32 v7, 2147483648
  v_cmp_gt_u32 vcc, 40, v1
  s_nop 1
  v_cndmask_b32 v9, v7, v8, vcc
  s_waitcnt lgkmcnt(0)
  ds_read_b128 v[32:35], v8 offset:5120
  ds_read_b128 v[36:39], v8 offset:5760
  ds_read_b128 v[40:43], v8 offset:6400
  ds_read_b128 v[44:47], v8 offset:7040
  s_waitcnt lgkmcnt(0)
  v_perm_b32 v32, v32, v10, s98
  v_perm_b32 v33, v33, v10, s99
  v_perm_b32 v34, v34, v10, s100
  v_perm_b32 v35, v35, v10, s101
  v_perm_b32 v36, v36, v10, s98
  v_perm_b32 v37, v37, v10, s99
  v_perm_b32 v38, v38, v10, s100
  v_perm_b32 v39, v39, v10, s101
  v_perm_b32 v40, v40, v10, s98
  v_perm_b32 v41, v41, v10, s99
  v_perm_b32 v42, v42, v10, s100
  v_perm_b32 v43, v43, v10, s101
  v_perm_b32 v44, v44, v10, s98
  v_perm_b32 v45, v45, v10, s99
  v_perm_b32 v46, v46, v10, s100
  v_perm_b32 v47, v47, v10, s101
  buffer_store_dwordx4 v[32:35], v9, s[36:39], s45 offen sc1
  s_add_u32 s45, s45, 40960
  buffer_store_dwordx4 v[36:39], v9, s[36:39], s45 offen sc1
  s_add_u32 s45, s45, 40960
  buffer_store_dwordx4 v[40:43], v9, s[36:39], s45 offen sc1
  s_add_u32 s45, s45, 40960
  buffer_store_dwordx4 v[44:47], v9, s[36:39], s45 offen sc1
  s_add_u32 s45, s45, 40960
L_fdone:
  s_waitcnt vmcnt(0)
L_wo:
  s_mul_i32 s34, s28, 163840
  s_mul_i32 s45, s3, 320
  s_add_u32 s34, s34, s45
  s_add_u32 s32, s12, s34
  s_addc_u32 s33, s13, 0
  s_sub_u32 s34, 163840, s45
  s_mov_b32 s35, 0x20000
  v_mul_u32_u24 v6, 10240, v2
  v_lshl_add_u32 v7, v3, 2, v6
  v_lshl_add_u32 v6, v3, 4, v6
  s_cmp_lg_u32 s3, 0
  s_cbranch_scc0 L_wo_mid
  s_cmp_eq_u32 s3, 2
  s_mov_b32 s40, 0
  buffer_load_dwordx4 v[96:99], v6, s[32:35], s40 offen
  buffer_load_dword v224, v7, s[32:35], s40 offen offset:256
  s_mov_b32 s40, 1280
  s_waitcnt vmcnt(6)
  s_cbranch_scc1 L_fs1
  s_waitcnt vmcnt(0)
L_fs1:
  buffer_load_dwordx4 v[100:103], v6, s[32:35], s40 offen
  buffer_load_dword v225, v7, s[32:35], s40 offen offset:256
  s_mov_b32 s40, 2560
  s_waitcnt vmcnt(6)
  s_cbranch_scc1 L_fs2
  s_waitcnt vmcnt(0)
L_fs2:
  buffer_load_dwordx4 v[104:107], v6, s[32:35], s40 offen
  buffer_load_dword v226, v7, s[32:35], s40 offen offset:256
L_wo_mid:
  s_mov_b32 s40, 3840
  s_waitcnt vmcnt(6)
  s_cbranch_scc1 L_fs3
  s_waitcnt vmcnt(0)
L_fs3:
  buffer_load_dwordx4 v[108:111], v6, s[32:35], s40 offen
  buffer_load_dword v227, v7, s[32:35], s40 offen offset:256
  s_mov_b32 s40, 5120
  s_waitcnt vmcnt(6)
  s_cbranch_scc1 L_fs4
  s_waitcnt vmcnt(0)
L_fs4:
  buffer_load_dwordx4 v[112:115], v6, s[32:35], s40 offen
  buffer_load_dword v228, v7, s[32:35], s40 offen offset:256
  s_mov_b32 s40, 6400
  s_waitcnt vmcnt(6)
  s_cbranch_scc1 L_fs5
  s_waitcnt vmcnt(0)
L_fs5:
  buffer_load_dwordx4 v[116:119], v6, s[32:35], s40 offen
  buffer_load_dword v229, v7, s[32:35], s40 offen offset:256
  s_mov_b32 s40, 7680
  s_waitcnt vmcnt(6)
  s_cbranch_scc1 L_fs6
  s_waitcnt vmcnt(0)
L_fs6:
  buffer_load_dwordx4 v[120:123], v6, s[32:35], s40 offen
  buffer_load_dword v230, v7, s[32:35], s40 offen offset:256
  s_mov_b32 s40, 8960
  s_waitcnt vmcnt(6)
  s_cbranch_scc1 L_fs7
  s_waitcnt vmcnt(0)
L_fs7:
  buffer_load_dwordx4 v[124:127], v6, s[32:35], s40 offen
  buffer_load_dword v231, v7, s[32:35], s40 offen offset:256
  s_mov_b32 s40, 40960
  s_waitcnt vmcnt(6)
  s_cbranch_scc1 L_fs8
  s_waitcnt vmcnt(0)
L_fs8:
  buffer_load_dwordx4 v[128:131], v6, s[32:35], s40 offen
  buffer_load_dword v232, v7, s[32:35], s40 offen offset:256
  s_mov_b32 s40, 42240
  s_waitcnt vmcnt(6)
  s_cbranch_scc1 L_fs9
  s_waitcnt vmcnt(0)
L_fs9:
  buffer_load_dwordx4 v[132:135], v6, s[32:35], s40 offen
  buffer_load_dword v233, v7, s[32:35], s40 offen offset:256
  s_mov_b32 s40, 43520
  s_waitcnt vmcnt(6)
  s_cbranch_scc1 L_fs10
  s_waitcnt vmcnt(0)
L_fs10:
  buffer_load_dwordx4 v[136:139], v6, s[32:35], s40 offen
  buffer_load_dword v234, v7, s[32:35], s40 offen offset:256
  s_mov_b32 s40, 44800
  s_waitcnt vmcnt(6)
  s_cbranch_scc1 L_fs11
  s_waitcnt vmcnt(0)
L_fs11:
  buffer_load_dwordx4 v[140:143], v6, s[32:35], s40 offen
  buffer_load_dword v235, v7, s[32:35], s40 offen offset:256
  s_mov_b32 s40, 46080
  s_waitcnt vmcnt(6)
  s_cbranch_scc1 L_fs12
  s_waitcnt vmcnt(0)
L_fs12:
  buffer_load_dwordx4 v[144:147], v6, s[32:35], s40 offen
  buffer_load_dword v236, v7, s[32:35], s40 offen offset:256
  s_mov_b32 s40, 47360
  s_waitcnt vmcnt(6)
  s_cbranch_scc1 L_fs13
  s_waitcnt vmcnt(0)
L_fs13:
  buffer_load_dwordx4 v[148:151], v6, s[32:35], s40 offen
  buffer_load_dword v237, v7, s[32:35], s40 offen offset:256
  s_mov_b32 s40, 48640
  s_waitcnt vmcnt(6)
  s_cbranch_scc1 L_fs14
  s_waitcnt vmcnt(0)
L_fs14:
  buffer_load_dwordx4 v[152:155], v6, s[32:35], s40 offen
  buffer_load_dword v238, v7, s[32:35], s40 offen offset:256
  s_mov_b32 s40, 49920
  s_waitcnt vmcnt(6)
  s_cbranch_scc1 L_fs15
  s_waitcnt vmcnt(0)
L_fs15:
  buffer_load_dwordx4 v[156:159], v6, s[32:35], s40 offen
  buffer_load_dword v239, v7, s[32:35], s40 offen offset:256
  s_mov_b32 s40, 81920
  s_waitcnt vmcnt(6)
  s_cbranch_scc1 L_fs16
  s_waitcnt vmcnt(0)
L_fs16:
  buffer_load_dwordx4 v[160:163], v6, s[32:35], s40 offen
  buffer_load_dword v240, v7, s[32:35], s40 offen offset:256
  s_mov_b32 s40, 83200
  s_waitcnt vmcnt(6)
  s_cbranch_scc1 L_fs17
  s_waitcnt vmcnt(0)
L_fs17:
  buffer_load_dwordx4 v[164:167], v6, s[32:35], s40 offen
  buffer_load_dword v241, v7, s[32:35], s40 offen offset:256
  s_mov_b32 s40, 84480
  s_waitcnt vmcnt(6)
  s_cbranch_scc1 L_fs18
  s_waitcnt vmcnt(0)
L_fs18:
  buffer_load_dwordx4 v[168:171], v6, s[32:35], s40 offen
  buffer_load_dword v242, v7, s[32:35], s40 offen offset:256
  s_mov_b32 s40, 85760
  s_waitcnt vmcnt(6)
  s_cbranch_scc1 L_fs19
  s_waitcnt vmcnt(0)
L_fs19:
  buffer_load_dwordx4 v[172:175], v6, s[32:35], s40 offen
  buffer_load_dword v243, v7, s[32:35], s40 offen offset:256
  s_mov_b32 s40, 87040
  s_waitcnt vmcnt(6)
  s_cbranch_scc1 L_fs20
  s_waitcnt vmcnt(0)
L_fs20:
  buffer_load_dwordx4 v[176:179], v6, s[32:35], s40 offen
  buffer_load_dword v244, v7, s[32:35], s40 offen offset:256
  s_mov_b32 s40, 88320
  s_waitcnt vmcnt(6)
  s_cbranch_scc1 L_fs21
  s_waitcnt vmcnt(0)
L_fs21:
  buffer_load_dwordx4 v[180:183], v6, s[32:35], s40 offen
  buffer_load_dword v245, v7, s[32:35], s40 offen offset:256
  s_mov_b32 s40, 89600
  s_waitcnt vmcnt(6)
  s_cbranch_scc1 L_fs22
  s_waitcnt vmcnt(0)
L_fs22:
  buffer_load_dwordx4 v[184:187], v6, s[32:35], s40 offen
  buffer_load_dword v246, v7, s[32:35], s40 offen offset:256
  s_mov_b32 s40, 90880
  s_waitcnt vmcnt(6)
  s_cbranch_scc1 L_fs23
  s_waitcnt vmcnt(0)
L_fs23:
  buffer_load_dwordx4 v[188:191], v6, s[32:35], s40 offen
  buffer_load_dword v247, v7, s[32:35], s40 offen offset:256
  s_mov_b32 s40, 122880
  s_waitcnt vmcnt(6)
  s_cbranch_scc1 L_fs24
  s_waitcnt vmcnt(0)
L_fs24:
  buffer_load_dwordx4 v[192:195], v6, s[32:35], s40 offen
  buffer_load_dword v248, v7, s[32:35], s40 offen offset:256
  s_mov_b32 s40, 124160
  s_waitcnt vmcnt(6)
  s_cbranch_scc1 L_fs25
  s_waitcnt vmcnt(0)
L_fs25:
  buffer_load_dwordx4 v[196:199], v6, s[32:35], s40 offen
  buffer_load_dword v249, v7, s[32:35], s40 offen offset:256
  s_mov_b32 s40, 125440
  s_waitcnt vmcnt(6)
  s_cbranch_scc1 L_fs26
  s_waitcnt vmcnt(0)
L_fs26:
  buffer_load_dwordx4 v[200:203], v6, s[32:35], s40 offen
  buffer_load_dword v250, v7, s[32:35], s40 offen offset:256
  s_mov_b32 s40, 126720
  s_waitcnt vmcnt(6)
  s_cbranch_scc1 L_fs27
  s_waitcnt vmcnt(0)
L_fs27:
  buffer_load_dwordx4 v[204:207], v6, s[32:35], s40 offen
  buffer_load_dword v251, v7, s[32:35], s40 offen offset:256
  s_mov_b32 s40, 128000
  s_waitcnt vmcnt(6)
  s_cbranch_scc1 L_fs28
  s_waitcnt vmcnt(0)
L_fs28:
  buffer_load_dwordx4 v[208:211], v6, s[32:35], s40 offen
  buffer_load_dword v252, v7, s[32:35], s40 offen offset:256
  s_mov_b32 s40, 129280
  s_waitcnt vmcnt(6)
  s_cbranch_scc1 L_fs29
  s_waitcnt vmcnt(0)
L_fs29:
  buffer_load_dwordx4 v[212:215], v6, s[32:35], s40 offen
  buffer_load_dword v253, v7, s[32:35], s40 offen offset:256
  s_mov_b32 s40, 130560
  s_waitcnt vmcnt(6)
  s_cbranch_scc1 L_fs30
  s_waitcnt vmcnt(0)
L_fs30:
  buffer_load_dwordx4 v[216:219], v6, s[32:35], s40 offen
  buffer_load_dword v254, v7, s[32:35], s40 offen offset:256
  s_mov_b32 s40, 131840
  s_waitcnt vmcnt(6)
  s_cbranch_scc1 L_fs31
  s_waitcnt vmcnt(0)
L_fs31:
  buffer_load_dwordx4 v[220:223], v6, s[32:35], s40 offen
  buffer_load_dword v255, v7, s[32:35], s40 offen offset:256
  s_waitcnt vmcnt(0)
  v_perm_b32 v64, v100, v96, s41
  v_perm_b32 v65, v108, v104, s41
  v_perm_b32 v66, v116, v112, s41
  v_perm_b32 v67, v124, v120, s41
  v_perm_b32 v68, v100, v96, s42
  v_perm_b32 v69, v108, v104, s42
  v_perm_b32 v70, v116, v112, s42
  v_perm_b32 v71, v124, v120, s42
  v_perm_b32 v72, v101, v97, s41
  v_perm_b32 v73, v109, v105, s41
  v_perm_b32 v74, v117, v113, s41
  v_perm_b32 v75, v125, v121, s41
  v_perm_b32 v76, v101, v97, s42
  v_perm_b32 v77, v109, v105, s42
  v_perm_b32 v78, v117, v113, s42
  v_perm_b32 v79, v125, v121, s42
  v_perm_b32 v80, v102, v98, s41
  v_perm_b32 v81, v110, v106, s41
  v_perm_b32 v82, v118, v114, s41
  v_perm_b32 v83, v126, v122, s41
  v_perm_b32 v84, v102, v98, s42
  v_perm_b32 v85, v110, v106, s42
  v_perm_b32 v86, v118, v114, s42
  v_perm_b32 v87, v126, v122, s42
  v_perm_b32 v88, v103, v99, s41
  v_perm_b32 v89, v111, v107, s41
  v_perm_b32 v90, v119, v115, s41
  v_perm_b32 v91, v127, v123, s41
  v_perm_b32 v92, v103, v99, s42
  v_perm_b32 v93, v111, v107, s42
  v_perm_b32 v94, v119, v115, s42
  v_perm_b32 v95, v127, v123, s42
  v_perm_b32 v96, v132, v128, s41
  v_perm_b32 v97, v140, v136, s41
  v_perm_b32 v98, v148, v144, s41
  v_perm_b32 v99, v156, v152, s41
  v_perm_b32 v100, v132, v128, s42
  v_perm_b32 v101, v140, v136, s42
  v_perm_b32 v102, v148, v144, s42
  v_perm_b32 v103, v156, v152, s42
  v_perm_b32 v104, v133, v129, s41
  v_perm_b32 v105, v141, v137, s41
  v_perm_b32 v106, v149, v145, s41
  v_perm_b32 v107, v157, v153, s41
  v_perm_b32 v108, v133, v129, s42
  v_perm_b32 v109, v141, v137, s42
  v_perm_b32 v110, v149, v145, s42
  v_perm_b32 v111, v157, v153, s42
  v_perm_b32 v112, v134, v130, s41
  v_perm_b32 v113, v142, v138, s41
  v_perm_b32 v114, v150, v146, s41
  v_perm_b32 v115, v158, v154, s41
  v_perm_b32 v116, v134, v130, s42
  v_perm_b32 v117, v142, v138, s42
  v_perm_b32 v118, v150, v146, s42
  v_perm_b32 v119, v158, v154, s42
  v_perm_b32 v120, v135, v131, s41
  v_perm_b32 v121, v143, v139, s41
  v_perm_b32 v122, v151, v147, s41
  v_perm_b32 v123, v159, v155, s41
  v_perm_b32 v124, v135, v131, s42
  v_perm_b32 v125, v143, v139, s42
  v_perm_b32 v126, v151, v147, s42
  v_perm_b32 v127, v159, v155, s42
  v_perm_b32 v128, v164, v160, s41
  v_perm_b32 v129, v172, v168, s41
  v_perm_b32 v130, v180, v176, s41
  v_perm_b32 v131, v188, v184, s41
  v_perm_b32 v132, v164, v160, s42
  v_perm_b32 v133, v172, v168, s42
  v_perm_b32 v134, v180, v176, s42
  v_perm_b32 v135, v188, v184, s42
  v_perm_b32 v136, v165, v161, s41
  v_perm_b32 v137, v173, v169, s41
  v_perm_b32 v138, v181, v177, s41
  v_perm_b32 v139, v189, v185, s41
  v_perm_b32 v140, v165, v161, s42
  v_perm_b32 v141, v173, v169, s42
  v_perm_b32 v142, v181, v177, s42
  v_perm_b32 v143, v189, v185, s42
  v_perm_b32 v144, v166, v162, s41
  v_perm_b32 v145, v174, v170, s41
  v_perm_b32 v146, v182, v178, s41
  v_perm_b32 v147, v190, v186, s41
  v_perm_b32 v148, v166, v162, s42
  v_perm_b32 v149, v174, v170, s42
  v_perm_b32 v150, v182, v178, s42
  v_perm_b32 v151, v190, v186, s42
  v_perm_b32 v152, v167, v163, s41
  v_perm_b32 v153, v175, v171, s41
  v_perm_b32 v154, v183, v179, s41
  v_perm_b32 v155, v191, v187, s41
  v_perm_b32 v156, v167, v163, s42
  v_perm_b32 v157, v175, v171, s42
  v_perm_b32 v158, v183, v179, s42
  v_perm_b32 v159, v191, v187, s42
  v_perm_b32 v160, v196, v192, s41
  v_perm_b32 v161, v204, v200, s41
  v_perm_b32 v162, v212, v208, s41
  v_perm_b32 v163, v220, v216, s41
  v_perm_b32 v164, v196, v192, s42
  v_perm_b32 v165, v204, v200, s42
  v_perm_b32 v166, v212, v208, s42
  v_perm_b32 v167, v220, v216, s42
  v_perm_b32 v168, v197, v193, s41
  v_perm_b32 v169, v205, v201, s41
  v_perm_b32 v170, v213, v209, s41
  v_perm_b32 v171, v221, v217, s41
  v_perm_b32 v172, v197, v193, s42
  v_perm_b32 v173, v205, v201, s42
  v_perm_b32 v174, v213, v209, s42
  v_perm_b32 v175, v221, v217, s42
  v_perm_b32 v176, v198, v194, s41
  v_perm_b32 v177, v206, v202, s41
  v_perm_b32 v178, v214, v210, s41
  v_perm_b32 v179, v222, v218, s41
  v_perm_b32 v180, v198, v194, s42
  v_perm_b32 v181, v206, v202, s42
  v_perm_b32 v182, v214, v210, s42
  v_perm_b32 v183, v222, v218, s42
  v_perm_b32 v184, v199, v195, s41
  v_perm_b32 v185, v207, v203, s41
  v_perm_b32 v186, v215, v211, s41
  v_perm_b32 v187, v223, v219, s41
  v_perm_b32 v188, v199, v195, s42
  v_perm_b32 v189, v207, v203, s42
  v_perm_b32 v190, v215, v211, s42
  v_perm_b32 v191, v223, v219, s42
  v_perm_b32 v192, v225, v224, s41
  v_perm_b32 v193, v227, v226, s41
  v_perm_b32 v194, v229, v228, s41
  v_perm_b32 v195, v231, v230, s41
  v_perm_b32 v196, v225, v224, s42
  v_perm_b32 v197, v227, v226, s42
  v_perm_b32 v198, v229, v228, s42
  v_perm_b32 v199, v231, v230, s42
  v_perm_b32 v200, v233, v232, s41
  v_perm_b32 v201, v235, v234, s41
  v_perm_b32 v202, v237, v236, s41
  v_perm_b32 v203, v239, v238, s41
  v_perm_b32 v204, v233, v232, s42
  v_perm_b32 v205, v235, v234, s42
  v_perm_b32 v206, v237, v236, s42
  v_perm_b32 v207, v239, v238, s42
  v_perm_b32 v208, v241, v240, s41
  v_perm_b32 v209, v243, v242, s41
  v_perm_b32 v210, v245, v244, s41
  v_perm_b32 v211, v247, v246, s41
  v_perm_b32 v212, v241, v240, s42
  v_perm_b32 v213, v243, v242, s42
  v_perm_b32 v214, v245, v244, s42
  v_perm_b32 v215, v247, v246, s42
  v_perm_b32 v216, v249, v248, s41
  v_perm_b32 v217, v251, v250, s41
  v_perm_b32 v218, v253, v252, s41
  v_perm_b32 v219, v255, v254, s41
  v_perm_b32 v220, v249, v248, s42
  v_perm_b32 v221, v251, v250, s42
  v_perm_b32 v222, v253, v252, s42
  v_perm_b32 v223, v255, v254, s42
L_wodone:
  s_and_b32 s45, s29, 1
  s_lshl_b32 s46, s28, 1
  s_add_u32 s87, s45, s46
  s_lshl_b32 s46, s30, 6
  s_add_u32 s46, s46, s87
  s_mul_i32 s63, s46, 2560
  s_mul_i32 s45, s3, 640
  s_add_u32 s63, s63, s45
  s_add_u32 s63, s63, 65536
  v_lshlrev_b32 v5, 4, v1
  v_mov_b32 v7, 2147483648
  v_cmp_gt_u32 vcc, 40, v1
  s_nop 1
  v_cndmask_b32 v5, v7, v5, vcc
  s_cmp_eq_u32 s3, 3
  s_cbranch_scc1 L_stats
  s_cmp_lg_u32 s3, 2
  s_cbranch_scc1 L_lead
  v_mov_b32 v6, 0
  v_lshlrev_b32 v7, 2, v1
  s_lshl_b32 s72, s61, 8
  s_mov_b32 s73, 1
  s_mul_i32 s77, s89, 384
  s_add_u32 s77, s77, 917504
  s_lshl_b32 s74, s31, 2
  s_add_u32 s74, s74, s77
  s_mov_b32 s90, 0
  s_mov_b32 s78, -1
  s_mov_b32 s79, 1
  s_mov_b64 exec, s[78:79]
L_mon:
  ds_read_b128 v[232:235], v6 offset:27008
  s_waitcnt lgkmcnt(0)
  v_min3_u32 v246, v232, v233, v234
  v_min_u32 v246, v246, v235
  s_nop 0
  v_readfirstlane_b32 s45, v246
  s_nop 0
  s_cmp_ge_u32 s45, s73
  s_nop 1
  s_cbranch_scc1 L_mon_go
  s_sleep 2
  s_add_u32 s90, s90, 1
  s_cmp_lt_u32 s90, 1048576
  s_cbranch_scc1 L_mon
  s_branch L_mon_end
L_mon_go:
  buffer_load_dword v236, v7, s[36:39], s77 offen sc1
  s_mov_b32 s73, s45
  s_add_u32 s76, s72, s73
  v_mov_b32 v237, s76
  s_waitcnt vmcnt(0)
  s_mov_b64 exec, 1
  buffer_store_dword v237, v6, s[36:39], s74 offen
  s_mov_b64 exec, s[78:79]
  s_waitcnt vmcnt(1)
  v_subrev_u32 v236, s76, v236
  v_cmp_gt_u32 vcc, 32, v236
  s_nop 0
  s_bcnt1_i32_b32 s45, vcc_lo
  s_cmp_ge_u32 s45, 10
  s_cselect_b32 s45, 1, 0
  s_or_b32 s45, s45, vcc_hi
  v_mov_b32 v236, s45
  ds_write_b32 v6, v236 offset:27024
  s_add_u32 s73, s73, 1
  s_cmp_le_u32 s73, 12
  s_cbranch_scc1 L_mon
L_mon_end:
  s_mov_b64 exec, -1
  s_branch L_addr
L_lead:
  s_cmp_lg_u32 s3, 1
  s_cbranch_scc1 L_addr
  s_cmp_lg_u32 s31, 21
  s_cbranch_scc1 L_addr
  v_mov_b32 v6, 0
  v_lshlrev_b32 v7, 2, v1
  v_mul_u32_u24 v8, 384, v1
  s_lshl_b32 s72, s61, 8
  s_add_u32 s76, s72, 6
  s_add_u32 s73, s72, 11
  s_mul_i32 s77, s89, 384
  s_add_u32 s74, s77, 933888
  s_add_u32 s77, s77, 917504
  s_mov_b32 s75, 933888
  s_mov_b32 s90, 0
  s_mov_b32 s78, -1
  s_mov_b32 s79, 0
L_ld:
  s_mov_b64 exec, s[78:79]
  buffer_load_dword v236, v7, s[36:39], s77 offen sc1
  s_waitcnt vmcnt(0)
  v_subrev_u32 v236, s76, v236
  v_cmp_gt_u32 vcc, 32, v236
  s_nop 0
  s_bcnt1_i32_b64 s45, vcc
  s_cmp_ge_u32 s45, 16
  s_nop 0
  s_cbranch_scc1 L_ld_go
  ds_read_b32 v236, v6 offset:27008
  s_add_u32 s90, s90, 1
  s_cmp_ge_u32 s90, 65536
  s_cbranch_scc1 L_ld_end
  s_waitcnt lgkmcnt(0)
  v_readfirstlane_b32 s45, v236
  s_nop 0
  s_cmp_le_u32 s45, 12
  s_nop 1
  s_cbranch_scc1 L_ld
  s_branch L_ld_end
L_ld_go:
  s_mov_b64 exec, 0xff
  buffer_load_dword v236, v8, s[36:39], s75 offen sc1
  v_mov_b32 v237, s76
  s_mov_b64 exec, 1
  buffer_store_dword v237, v6, s[36:39], s74 offen sc1
  s_mov_b64 exec, 0xff
  s_waitcnt vmcnt(1)
  v_cmp_eq_u32 vcc, s76, v236
  s_nop 0
  s_bcnt1_i32_b64 s45, vcc
  s_cmp_lt_u32 s45, 3
  s_nop 0
  s_cbranch_scc1 L_ld_nx
  s_add_u32 s45, s76, 1
  v_mov_b32 v237, s45
  s_mov_b64 exec, 1
  buffer_store_dword v237, v6, s[36:39], s77 offen offset:128
L_ld_nx:
  s_add_u32 s74, s74, 3072
  s_add_u32 s75, s75, 3072
  s_add_u32 s76, s76, 2
  s_cmp_le_u32 s76, s73
  s_cbranch_scc1 L_ld
L_ld_end:
  s_mov_b64 exec, -1
  s_branch L_addr
L_stats:
  v_lshlrev_b32 v4, 4, v2
  s_mov_b32 s90, 0
L_ml:
  ds_read_b128 v[236:239], v4 offset:26944
  ds_read_b128 v[232:235], v4 offset:26880
  s_waitcnt lgkmcnt(0)
  v_min3_f32 v246, v236, v237, v238
  v_min_f32 v246, v246, v239
  v_cmp_gt_f32 vcc, 0, v246
  s_nop 0
  s_cmp_eq_u64 vcc, 0
  s_nop 1
  s_cbranch_scc1 L_ml_ok
  s_sleep 32
  s_add_u32 s90, s90, 1
  s_cmp_lt_u32 s90, 65536
  s_cbranch_scc1 L_ml
L_ml_ok:
  v_max3_f32 v244, v232, v233, v234
  v_max_f32 v244, v244, v235
  v_mov_b32 v246, v244
  s_nop 1
  v_permlane16_swap_b32 v244, v246
  v_max_f32 v244, v244, v246
  v_mov_b32 v246, v244
  s_nop 1
  v_permlane32_swap_b32 v244, v246
  v_max_f32 v244, v244, v246
  v_sub_f32 v240, v232, v244
  v_sub_f32 v241, v233, v244
  v_sub_f32 v242, v234, v244
  v_sub_f32 v243, v235, v244
  v_exp_f32 v240, v240
  v_exp_f32 v241, v241
  v_exp_f32 v242, v242
  v_exp_f32 v243, v243
  v_mul_f32 v245, v240, v236
  v_fmac_f32 v245, v241, v237
  v_fmac_f32 v245, v242, v238
  v_fmac_f32 v245, v243, v239
  v_mov_b32 v246, v245
  s_nop 1
  v_permlane16_swap_b32 v245, v246
  v_add_f32 v245, v245, v246
  v_mov_b32 v246, v245
  s_nop 1
  v_permlane32_swap_b32 v245, v246
  v_add_f32 v245, v245, v246
  v_xor_b32 v246, s61, v244
  v_xor_b32 v247, s61, v245
  s_lshl_b32 s47, s46, 7
  s_add_u32 s47, s47, 4096
  v_mov_b32 v6, 0
  s_mov_b64 exec, 1
  buffer_store_dwordx4 v[244:247], v6, s[36:39], s47 offen sc1
  s_mov_b64 exec, -1
  s_xor_b32 s47, s47, 128
  s_mov_b32 s90, 0
L_px:
  s_sleep 127
  buffer_load_dwordx4 v[232:235], v6, s[36:39], s47 offen sc1
  s_waitcnt vmcnt(0)
  v_bitop3_b32 v236, v232, v234, v10 bitop3:0x96
  v_bitop3_b32 v237, v233, v235, v10 bitop3:0x96
  v_or_b32 v236, v236, v237
  v_cmp_ne_u32 vcc, 0, v236
  s_nop 0
  s_cmp_eq_u64 vcc, 0
  s_nop 1
  s_cbranch_scc1 L_px_ok
  s_add_u32 s90, s90, 1
  s_cmp_lt_u32 s90, 65536
  s_cbranch_scc1 L_px
L_px_ok:
  v_max_f32 v246, v244, v232
  v_sub_f32 v236, v244, v246
  v_sub_f32 v237, v232, v246
  v_exp_f32 v236, v236
  v_exp_f32 v237, v237
  v_mul_f32 v246, v236, v245
  v_fmac_f32 v246, v237, v233
  v_rcp_f32 v246, v246
  s_nop 0
  v_mul_f32 v246, v246, v236
  v_mul_f32 v240, v240, v246
  v_mul_f32 v241, v241, v246
  v_mul_f32 v242, v242, v246
  v_mul_f32 v243, v243, v246
  ds_write_b128 v4, v[240:243] offset:27072
  s_waitcnt lgkmcnt(0)
L_addr:
  v_lshlrev_b32 v254, 4, v2
  s_mul_i32 s45, s3, 5120
  v_lshlrev_b32 v8, 5, v3
  v_lshl_add_u32 v8, v2, 3, v8
  v_add_u32 v8, s45, v8
  v_lshlrev_b32 v9, 3, v3
  v_lshrrev_b32 v6, 1, v2
  v_lshl_add_u32 v9, v6, 2, v9
  v_add_u32 v9, s45, v9
  v_lshlrev_b32 v5, 4, v1
  v_add_u32 v4, s45, v5
  v_mov_b32 v7, 2147483648
  v_cmp_gt_u32 vcc, 40, v1
  s_nop 1
  v_cndmask_b32 v5, v7, v5, vcc
  v_mul_u32_u24 v11, 272, v3
  v_lshl_add_u32 v11, v2, 4, v11
  s_mov_b32 s88, 0
  s_cmp_lt_u32 s31, 22
  s_cbranch_scc1 L_bar2
  s_mul_i32 s91, s89, 10
  s_add_u32 s91, s91, s31
  s_sub_u32 s91, s91, 22
  s_and_b32 s30, s91, 3
  s_lshr_b32 s87, s91, 2
  s_cmp_lg_u32 s3, 0
  s_cbranch_scc1 L_watch
  s_mov_b32 s88, 1
  v_lshrrev_b32 v252, 3, v1
  v_mul_u32_u24 v252, 2560, v252
  v_and_b32 v6, 7, v1
  v_lshl_add_u32 v252, v6, 4, v252
  s_lshl_b32 s46, s87, 7
  s_mul_i32 s72, s30, 40960
  s_add_u32 s72, s72, s46
  s_add_u32 s72, s72, 720896
  s_add_u32 s73, s72, 20480
  v_lshlrev_b32 v253, 3, v6
  v_lshl_add_u32 v253, v2, 1, v253
  s_mul_i32 s45, s30, 1280
  s_lshl_b32 s62, s87, 6
  s_add_u32 s62, s62, s45
  buffer_load_ushort v250, v253, s[48:51], s62 offen
  v_and_b32 v6, 8, v1
  v_cmp_eq_u32 vcc, 0, v6
  s_nop 1
  v_cndmask_b32 v253, v7, v253, vcc
  s_mov_b32 s90, 0
  s_nop 0
L_pu3:
  buffer_load_dwordx4 v[32:35], v252, s[36:39], s72 offen sc1
  s_waitcnt vmcnt(0)
  v_xor_b32 v32, s94, v32
  v_xor_b32 v33, s95, v33
  v_xor_b32 v34, s96, v34
  v_xor_b32 v35, s97, v35
  v_or_b32 v40, v32, v33
  v_or3_b32 v40, v40, v34, v35
  v_and_b32 v40, 0xff, v40
  v_cmp_ne_u32 vcc, 0, v40
  s_nop 0
  s_cmp_eq_u64 vcc, 0
  s_nop 1
  s_cbranch_scc1 L_pu3_ok
  s_mov_b64 exec, vcc
  s_sleep 64
  s_add_u32 s90, s90, 1
  s_cmp_lt_u32 s90, 65536
  s_cbranch_scc1 L_pu3
L_pu3_ok:
  s_mov_b64 exec, -1
  v_mov_b32 v36, 0
  v_mov_b32 v37, 0
  v_mov_b32 v38, 0
  v_mov_b32 v39, 0
  s_mov_b32 s74, -1
  s_mov_b32 s75, 0xffff
  s_mov_b32 s90, 0
  s_mov_b64 exec, s[74:75]
L_pu4:
  buffer_load_dwordx4 v[36:39], v252, s[36:39], s73 offen sc1
  s_waitcnt vmcnt(0)
  v_xor_b32 v36, s94, v36
  v_xor_b32 v37, s95, v37
  v_xor_b32 v38, s96, v38
  v_xor_b32 v39, s97, v39
  v_or_b32 v40, v36, v37
  v_or3_b32 v40, v40, v38, v39
  v_and_b32 v40, 0xff, v40
  v_cmp_ne_u32 vcc, 0, v40
  s_nop 0
  s_cmp_eq_u64 vcc, 0
  s_nop 1
  s_cbranch_scc1 L_pu4_ok
  s_mov_b64 exec, vcc
  s_sleep 64
  s_add_u32 s90, s90, 1
  s_cmp_lt_u32 s90, 65536
  s_cbranch_scc1 L_pu4
L_pu4_ok:
  s_mov_b64 exec, -1
  v_add_f32 v32, v32, v36
  v_add_f32 v33, v33, v37
  v_add_f32 v34, v34, v38
  v_add_f32 v35, v35, v39
  s_nop 0
  v_permlane32_swap_b32 v32, v34
  v_permlane32_swap_b32 v33, v35
  v_add_f32 v32, v32, v34
  v_add_f32 v33, v33, v35
  s_nop 1
  v_permlane16_swap_b32 v32, v33
  v_add_f32 v32, v32, v33
  s_nop 1
  v_add_f32_dpp v32, v32, v32 row_ror:8 row_mask:0xf bank_mask:0xf
  v_cvt_pk_bf16_f32 v32, v32, v32
  v_and_b32 v32, 0xffff0000, v32
  v_mul_f32 v251, 0xbfb8aa3b, v32
  v_exp_f32 v251, v251
  s_nop 0
  v_add_f32 v251, 1.0, v251
  v_rcp_f32 v251, v251
  s_nop 0
  v_mul_f32 v251, v251, v32
  v_cvt_pk_bf16_f32 v251, v251, v251
  v_and_b32 v251, 0xffff0000, v251
  v_lshlrev_b32 v250, 16, v250
  v_lshlrev_b32 v6, 3, v1
  ds_write_b64 v6, v[250:251] offset:20480
  s_waitcnt lgkmcnt(0)
  s_branch L_bar2
L_watch:
  s_cmp_lg_u32 s91, 0
  s_cbranch_scc1 L_bar2
  s_cmp_lg_u32 s3, 1
  s_cbranch_scc1 L_bar2
  v_mov_b32 v6, 0
  v_lshlrev_b32 v252, 7, v1
  s_mov_b32 s72, 4096
  s_mov_b32 s73, 12288
  s_mov_b32 s74, 20480
  s_mov_b32 s75, 28672
  s_mov_b32 s90, 0
L_ep:
  s_sleep 64
  s_add_u32 s90, s90, 1
  s_cmp_ge_u32 s90, 65536
  s_cbranch_scc1 L_bar2
  ds_read_b32 v32, v6 offset:27008
  s_waitcnt lgkmcnt(0)
  v_readfirstlane_b32 s45, v32
  s_nop 0
  s_cmp_lt_u32 s45, 9
  s_nop 1
  s_cbranch_scc1 L_ep
  buffer_load_dwordx4 v[32:35], v252, s[36:39], s72 offen sc1
  buffer_load_dwordx4 v[36:39], v252, s[36:39], s73 offen sc1
  buffer_load_dwordx4 v[40:43], v252, s[36:39], s74 offen sc1
  buffer_load_dwordx4 v[44:47], v252, s[36:39], s75 offen sc1
  s_waitcnt vmcnt(0)
  v_bitop3_b32 v32, v32, v34, v10 bitop3:0x96
  v_bitop3_b32 v36, v36, v38, v10 bitop3:0x96
  v_bitop3_b32 v40, v40, v42, v10 bitop3:0x96
  v_bitop3_b32 v44, v44, v46, v10 bitop3:0x96
  v_or_b32 v32, v32, v36
  v_or3_b32 v32, v32, v40, v44
  v_cmp_ne_u32 vcc, 0, v32
  s_nop 0
  s_cmp_lg_u64 vcc, 0
  s_nop 1
  s_cbranch_scc1 L_ep
  s_mov_b64 exec, 1
  buffer_store_dword v10, v6, s[36:39], 0 offen offset:0 sc1
  s_mov_b64 exec, -1
L_bar2:
  s_barrier
  ds_read_b128 v[12:15], v11 offset:22528
  ds_read_b128 v[16:19], v11 offset:22592
  ds_read_b128 v[20:23], v11 offset:22656
  ds_read_b128 v[24:27], v11 offset:22720
  ds_read_b128 v[240:243], v254 offset:27072
  s_waitcnt lgkmcnt(4)
  v_mfma_f32_16x16x32_bf16 v[224:227], v[12:15], v[192:195], 0
  v_mfma_f32_16x16x32_bf16 v[228:231], v[12:15], v[196:199], 0
  s_waitcnt lgkmcnt(3)
  v_mfma_f32_16x16x32_bf16 v[224:227], v[16:19], v[200:203], v[224:227]
  v_mfma_f32_16x16x32_bf16 v[228:231], v[16:19], v[204:207], v[228:231]
  s_waitcnt lgkmcnt(2)
  v_mfma_f32_16x16x32_bf16 v[224:227], v[20:23], v[208:211], v[224:227]
  v_mfma_f32_16x16x32_bf16 v[228:231], v[20:23], v[212:215], v[228:231]
  s_waitcnt lgkmcnt(1)
  v_mfma_f32_16x16x32_bf16 v[224:227], v[24:27], v[216:219], v[224:227]
  v_mfma_f32_16x16x32_bf16 v[228:231], v[24:27], v[220:223], v[228:231]
  v_mfma_f32_16x16x32_bf16 v[32:35], v[12:15], v[64:67], 0
  v_mfma_f32_16x16x32_bf16 v[32:35], v[16:19], v[96:99], v[32:35]
  v_mfma_f32_16x16x32_bf16 v[32:35], v[20:23], v[128:131], v[32:35]
  v_mfma_f32_16x16x32_bf16 v[32:35], v[24:27], v[160:163], v[32:35]
  v_mfma_f32_16x16x32_bf16 v[36:39], v[12:15], v[68:71], 0
  v_mfma_f32_16x16x32_bf16 v[36:39], v[16:19], v[100:103], v[36:39]
  v_mfma_f32_16x16x32_bf16 v[36:39], v[20:23], v[132:135], v[36:39]
  v_mfma_f32_16x16x32_bf16 v[36:39], v[24:27], v[164:167], v[36:39]
  s_waitcnt lgkmcnt(0)
  v_mfma_f32_16x16x32_bf16 v[40:43], v[12:15], v[72:75], 0
  v_mul_f32 v28, v240, v224
  v_fmac_f32 v28, v241, v225
  v_mfma_f32_16x16x32_bf16 v[40:43], v[16:19], v[104:107], v[40:43]
  v_fmac_f32 v28, v242, v226
  v_fmac_f32 v28, v243, v227
  v_mfma_f32_16x16x32_bf16 v[40:43], v[20:23], v[136:139], v[40:43]
  v_mul_f32 v29, v240, v228
  v_fmac_f32 v29, v241, v229
  v_mfma_f32_16x16x32_bf16 v[40:43], v[24:27], v[168:171], v[40:43]
  v_fmac_f32 v29, v242, v230
  v_fmac_f32 v29, v243, v231
  v_mfma_f32_16x16x32_bf16 v[44:47], v[12:15], v[76:79], 0
  s_nop 0
  v_permlane32_swap_b32 v28, v29
  v_add_f32 v28, v28, v29
  v_mfma_f32_16x16x32_bf16 v[44:47], v[16:19], v[108:111], v[44:47]
  v_mov_b32 v29, v28
  s_nop 1
  v_permlane16_swap_b32 v28, v29
  v_mfma_f32_16x16x32_bf16 v[44:47], v[20:23], v[140:143], v[44:47]
  v_add_f32 v28, v28, v29
  ds_write_b32 v9, v28 offset:512
  v_mfma_f32_16x16x32_bf16 v[44:47], v[24:27], v[172:175], v[44:47]
  v_mul_f32 v232, v240, v32
  v_fmac_f32 v232, v241, v33
  v_mfma_f32_16x16x32_bf16 v[48:51], v[12:15], v[80:83], 0
  v_fmac_f32 v232, v242, v34
  v_fmac_f32 v232, v243, v35
  v_mfma_f32_16x16x32_bf16 v[48:51], v[16:19], v[112:115], v[48:51]
  v_mul_f32 v233, v240, v36
  v_fmac_f32 v233, v241, v37
  v_mfma_f32_16x16x32_bf16 v[48:51], v[20:23], v[144:147], v[48:51]
  v_fmac_f32 v233, v242, v38
  v_fmac_f32 v233, v243, v39
  v_mfma_f32_16x16x32_bf16 v[48:51], v[24:27], v[176:179], v[48:51]
  v_mfma_f32_16x16x32_bf16 v[52:55], v[12:15], v[84:87], 0
  v_mul_f32 v234, v240, v40
  v_fmac_f32 v234, v241, v41
  v_mfma_f32_16x16x32_bf16 v[52:55], v[16:19], v[116:119], v[52:55]
  v_fmac_f32 v234, v242, v42
  v_fmac_f32 v234, v243, v43
  v_mfma_f32_16x16x32_bf16 v[52:55], v[20:23], v[148:151], v[52:55]
  v_mul_f32 v235, v240, v44
  v_fmac_f32 v235, v241, v45
  v_mfma_f32_16x16x32_bf16 v[52:55], v[24:27], v[180:183], v[52:55]
  v_fmac_f32 v235, v242, v46
  v_fmac_f32 v235, v243, v47
  v_mfma_f32_16x16x32_bf16 v[56:59], v[12:15], v[88:91], 0
  v_mul_f32 v236, v240, v48
  v_mfma_f32_16x16x32_bf16 v[56:59], v[16:19], v[120:123], v[56:59]
  v_fmac_f32 v236, v241, v49
  v_mfma_f32_16x16x32_bf16 v[56:59], v[20:23], v[152:155], v[56:59]
  v_fmac_f32 v236, v242, v50
  v_mfma_f32_16x16x32_bf16 v[56:59], v[24:27], v[184:187], v[56:59]
  v_fmac_f32 v236, v243, v51
  v_mfma_f32_16x16x32_bf16 v[60:63], v[12:15], v[92:95], 0
  v_mul_f32 v237, v240, v52
  v_mfma_f32_16x16x32_bf16 v[60:63], v[16:19], v[124:127], v[60:63]
  v_fmac_f32 v237, v241, v53
  v_mfma_f32_16x16x32_bf16 v[60:63], v[20:23], v[156:159], v[60:63]
  v_fmac_f32 v237, v242, v54
  v_mfma_f32_16x16x32_bf16 v[60:63], v[24:27], v[188:191], v[60:63]
  v_fmac_f32 v237, v243, v55
  v_mul_f32 v238, v240, v56
  v_fmac_f32 v238, v241, v57
  v_fmac_f32 v238, v242, v58
  v_fmac_f32 v238, v243, v59
  s_nop 2
  v_mul_f32 v239, v240, v60
  v_fmac_f32 v239, v241, v61
  v_fmac_f32 v239, v242, v62
  v_fmac_f32 v239, v243, v63
  v_permlane32_swap_b32 v232, v236
  v_permlane32_swap_b32 v233, v237
  v_permlane32_swap_b32 v234, v238
  v_permlane32_swap_b32 v235, v239
  v_add_f32 v232, v232, v236
  v_add_f32 v233, v233, v237
  v_add_f32 v234, v234, v238
  v_add_f32 v235, v235, v239
  s_nop 0
  v_permlane16_swap_b32 v232, v234
  v_permlane16_swap_b32 v233, v235
  v_add_f32 v232, v232, v234
  v_add_f32 v233, v233, v235
  ds_write_b64 v8, v[232:233] offset:0
  ds_read_b128 v[236:239], v4 offset:0
  s_waitcnt lgkmcnt(0)
  v_perm_b32 v236, v236, v10, s98
  v_perm_b32 v237, v237, v10, s99
  v_perm_b32 v238, v238, v10, s100
  v_perm_b32 v239, v239, v10, s101
  buffer_store_dwordx4 v[236:239], v5, s[36:39], s63 offen sc1
  s_nop 0
  s_branch L_fin
L_sred:
  ds_read_b64 v[68:69], v66 offset:20480
  s_mov_b32 s90, 0
L_pu5:
  buffer_load_dwordx4 v[128:131], v64, s[36:39], s72 offen sc1
  buffer_load_dwordx4 v[132:135], v64, s[36:39], s73 offen sc1
  buffer_load_dwordx4 v[136:139], v64, s[36:39], s74 offen sc1
  buffer_load_dwordx4 v[140:143], v64, s[36:39], s75 offen sc1
  buffer_load_dwordx4 v[144:147], v64, s[36:39], s76 offen sc1
  buffer_load_dwordx4 v[148:151], v64, s[36:39], s77 offen sc1
  buffer_load_dwordx4 v[152:155], v64, s[36:39], s78 offen sc1
  buffer_load_dwordx4 v[156:159], v64, s[36:39], s79 offen sc1
  s_waitcnt vmcnt(0)
  v_xor_b32 v128, s94, v128
  v_xor_b32 v129, s95, v129
  v_xor_b32 v130, s96, v130
  v_xor_b32 v131, s97, v131
  v_xor_b32 v132, s94, v132
  v_xor_b32 v133, s95, v133
  v_xor_b32 v134, s96, v134
  v_xor_b32 v135, s97, v135
  v_xor_b32 v136, s94, v136
  v_xor_b32 v137, s95, v137
  v_xor_b32 v138, s96, v138
  v_xor_b32 v139, s97, v139
  v_xor_b32 v140, s94, v140
  v_xor_b32 v141, s95, v141
  v_xor_b32 v142, s96, v142
  v_xor_b32 v143, s97, v143
  v_xor_b32 v144, s94, v144
  v_xor_b32 v145, s95, v145
  v_xor_b32 v146, s96, v146
  v_xor_b32 v147, s97, v147
  v_xor_b32 v148, s94, v148
  v_xor_b32 v149, s95, v149
  v_xor_b32 v150, s96, v150
  v_xor_b32 v151, s97, v151
  v_xor_b32 v152, s94, v152
  v_xor_b32 v153, s95, v153
  v_xor_b32 v154, s96, v154
  v_xor_b32 v155, s97, v155
  v_xor_b32 v156, s94, v156
  v_xor_b32 v157, s95, v157
  v_xor_b32 v158, s96, v158
  v_xor_b32 v159, s97, v159
  v_or_b32 v72, v128, v129
  v_or3_b32 v72, v72, v130, v131
  v_or3_b32 v72, v72, v132, v133
  v_or3_b32 v72, v72, v134, v135
  v_or3_b32 v72, v72, v136, v137
  v_or3_b32 v72, v72, v138, v139
  v_or3_b32 v72, v72, v140, v141
  v_or3_b32 v72, v72, v142, v143
  v_or3_b32 v72, v72, v144, v145
  v_or3_b32 v72, v72, v146, v147
  v_or3_b32 v72, v72, v148, v149
  v_or3_b32 v72, v72, v150, v151
  v_or3_b32 v72, v72, v152, v153
  v_or3_b32 v72, v72, v154, v155
  v_or3_b32 v72, v72, v156, v157
  v_or3_b32 v72, v72, v158, v159
  v_and_b32 v72, 0xff, v72
  v_cmp_ne_u32 vcc, 0, v72
  s_nop 0
  s_cmp_eq_u64 vcc, 0
  s_nop 1
  s_cbranch_scc1 L_pu5_ok
  s_mov_b64 exec, vcc
  s_add_u32 s90, s90, 1
  s_cmp_lt_u32 s90, 65536
  s_cbranch_scc1 L_pu5
L_pu5_ok:
  s_mov_b64 exec, -1
  v_pk_add_f32 v[96:97], v[128:129], v[144:145]
  v_pk_add_f32 v[98:99], v[130:131], v[146:147]
  v_pk_add_f32 v[100:101], v[132:133], v[148:149]
  v_pk_add_f32 v[102:103], v[134:135], v[150:151]
  v_pk_add_f32 v[104:105], v[136:137], v[152:153]
  v_pk_add_f32 v[106:107], v[138:139], v[154:155]
  v_pk_add_f32 v[108:109], v[140:141], v[156:157]
  v_pk_add_f32 v[110:111], v[142:143], v[158:159]
  v_pk_add_f32 v[96:97], v[96:97], v[104:105]
  v_pk_add_f32 v[98:99], v[98:99], v[106:107]
  v_pk_add_f32 v[100:101], v[100:101], v[108:109]
  v_pk_add_f32 v[102:103], v[102:103], v[110:111]
  v_pk_add_f32 v[96:97], v[96:97], v[100:101]
  v_pk_add_f32 v[98:99], v[98:99], v[102:103]
  s_nop 1
  v_permlane32_swap_b32 v96, v98
  v_permlane32_swap_b32 v97, v99
  v_add_f32 v96, v96, v98
  v_add_f32 v97, v97, v99
  s_nop 1
  v_permlane16_swap_b32 v96, v97
  v_add_f32 v96, v96, v97
  s_nop 1
  v_add_f32_dpp v96, v96, v96 row_ror:8 row_mask:0xf bank_mask:0xf
  v_cvt_pk_bf16_f32 v96, v96, v96
  v_and_b32 v96, 0xffff0000, v96
  s_waitcnt lgkmcnt(0)
  v_mul_f32 v96, v96, v69
  v_cvt_pk_bf16_f32 v96, v96, v96
  v_and_b32 v96, 0xffff0000, v96
  v_add_f32 v96, v96, v68
  v_cvt_pk_bf16_f32 v96, v96, v96
  buffer_store_short v96, v65, s[80:83], s63 offen
L_fin:
L_end:
  s_endpgm
L_codeend:
.section .rodata,"a"
.p2align 6
.amdhsa_kernel recurrent_scan__mha_block_cached__geglu_ffn__decode_kernel
  .amdhsa_next_free_vgpr 256
  .amdhsa_next_free_sgpr 102
  .amdhsa_accum_offset 256
  .amdhsa_group_segment_fixed_size 0
  .amdhsa_kernarg_size 96
  .amdhsa_user_sgpr_count 2
  .amdhsa_user_sgpr_kernarg_segment_ptr 1
  .amdhsa_system_sgpr_workgroup_id_x 1
.end_amdhsa_kernel
```
